```python
import torch

def _softmax(x, axis=-1):
    return torch.softmax(x, dim=axis)
def _gelu(x):
    return torch.nn.functional.gelu(x, approximate="tanh")
def _silu(x):
    return torch.nn.functional.silu(x)
def _sigmoid(x):
    return torch.sigmoid(x)
def _layernorm(x, axis=-1, eps=1e-5):
    m = x.mean(dim=axis, keepdim=True)
    v = x.var(dim=axis, keepdim=True, unbiased=False)
    return (x - m) / torch.sqrt(v + eps)
def _scatter_add(tgt, idx, src, axis=0):
    return tgt.clone().index_add_(axis, idx, src)
def _segment_sum(src, seg, n):
    out = torch.zeros((n,) + src.shape[1:], dtype=src.dtype)
    return out.index_add_(0, seg, src)
def _pad(x, pw):
    flat = tuple(v for pair in reversed(pw) for v in pair)
    return torch.nn.functional.pad(x, flat)

kernel_name = 'gated_mix__gqa_block_cached__glu_gated_reglu__decode'

def setup_inputs():

    _w = (lambda a: (lambda t: t.to(torch.bfloat16) if t.is_floating_point() else t)(torch.as_tensor(a)))
    def _A_setup():
        B, Sq, D = 8, 1, 640
        Hq, Hkv, Sk, Dh = 32, 32, 4096, 128
        assert Hq % Hkv == 0, (Hq, Hkv)
        return {
            "x": _w((lambda *s: torch.randn(*s, dtype=torch.bfloat16) * 0.05)(B, Sq, D)),
            "k_cache": _w((lambda *s: torch.randn(*s, dtype=torch.bfloat16) * 3.2)(B, Hkv, Sk, Dh)),
            "v_cache": _w((lambda *s: torch.randn(*s, dtype=torch.bfloat16) * 0.05)(B, Hkv, Sk, Dh)),
            "wq": _w((lambda *s: torch.randn(*s, dtype=torch.bfloat16) * 3.2)(D, Hq * Dh) * (D ** -0.5)),
            "wo": _w((lambda *s: torch.randn(*s, dtype=torch.bfloat16) * 0.05)(Hq * Dh, D) * ((Hq * Dh) ** -0.5)),
        }
    _A_in = _A_setup()

    def _B_setup():
        B, S, D, F = 8, 1, 640, 1728
        return {
            "x": _w((lambda *s: torch.randn(*s, dtype=torch.bfloat16) * 0.05)(B, S, D)),
            "W_gate": _w((lambda *s: torch.randn(*s, dtype=torch.bfloat16) * 0.2)(D, F) * (2.0 / D) ** 0.5),
            "W_up": _w((lambda *s: torch.randn(*s, dtype=torch.bfloat16) * 0.2)(D, F) * (2.0 / D) ** 0.5),
            "W_down": _w((lambda *s: torch.randn(*s, dtype=torch.bfloat16) * 0.2)(F, D) * (1.0 / F) ** 0.5),
        }
    _B_in = _B_setup()

    return {
        "A_x": _A_in["x"],
        "A_k_cache": _A_in["k_cache"],
        "A_v_cache": _A_in["v_cache"],
        "A_wq": _A_in["wq"],
        "A_wo": _A_in["wo"],
        "B_x": _B_in["x"],
        "B_W_gate": _B_in["W_gate"],
        "B_W_up": _B_in["W_up"],
        "B_W_down": _B_in["W_down"],
        "gate_w": _w((lambda *s: torch.randn(*s, dtype=torch.bfloat16) * 0.05)(640) * 16.0),
    }

def reference(A_x, A_k_cache, A_v_cache, A_wq, A_wo, B_x, B_W_gate, B_W_up, B_W_down, gate_w):
    def _A_ref(x, k_cache, v_cache, wq, wo):
        B, Sq, D = x.shape
        Hq, Dh = 32, 128
        Hkv = k_cache.shape[1]
        rep = Hq // Hkv
        q = (lambda x, *d: x.permute(*d))((x @ wq).reshape(B, Sq, Hq, Dh), 0, 2, 1, 3)
        k = (lambda x, n, axis: torch.repeat_interleave(x, n, dim=axis))(k_cache, rep, axis=1)
        v = (lambda x, n, axis: torch.repeat_interleave(x, n, dim=axis))(v_cache, rep, axis=1)
        scores = torch.einsum("bhqd,bhkd->bhqk", q, k) * (Dh ** -0.5)
        p = _softmax(scores, axis=-1)
        o = torch.einsum("bhqk,bhkd->bhqd", p, v)
        return (lambda x, *d: x.permute(*d))(o, 0, 2, 1, 3).reshape(B, Sq, Hq * Dh) @ wo

    def _B_ref(x, W_gate, W_up, W_down):
        gate = torch.einsum("bsd,df->bsf", x, W_gate)
        up = torch.einsum("bsd,df->bsf", x, W_up)
        gate = gate * (lambda x, dt: x.to(dt))(gate > 0, gate.dtype)
        h = gate * up
        return torch.einsum("bsf,fd->bsd", h, W_down)

    x = A_x
    g = _sigmoid((x * gate_w).sum(-1, keepdims=True))
    a = _A_ref(x, A_k_cache, A_v_cache, A_wq, A_wo)
    b = _B_ref(x, B_W_gate, B_W_up, B_W_down)
    return g * a + (1 - g) * b
```

```asm
; @launch grid=(256,1,1) block=(512,1,1) lds=155136
.amdgcn_target "amdgcn-amd-amdhsa--gfx950"
.text
.globl gated_mix__gqa_block_cached__glu_gated_reglu__decode_kernel
.p2align 8
.type gated_mix__gqa_block_cached__glu_gated_reglu__decode_kernel,@function
gated_mix__gqa_block_cached__glu_gated_reglu__decode_kernel:
    s_cmp_ge_u32 s2, 256
    s_cbranch_scc1 L_end
    s_load_dwordx4 s[4:7], s[0:1], 8
    v_lshrrev_b32 v1, 6, v0
    v_and_b32 v0, 63, v0
    s_and_b32 s16, s2, 7
    s_lshl_b32 s16, s16, 2
    s_bfe_u32 s3, s2, 0x20003
    v_readfirstlane_b32 s19, v1
    s_add_u32 s16, s16, s3
    s_lshr_b32 s17, s2, 5
    s_lshl_b32 s18, s17, 5
    s_add_u32 s18, s18, s16
    s_cmp_lg_u32 s19, 0
    s_cbranch_scc1 L_notloader
    s_setprio 3
    v_lshrrev_b32 v8, 4, v0
    v_and_b32 v9, 15, v0
    v_add_u32 v10, 0, v8
    v_xor_b32 v10, v10, v9
    v_lshlrev_b32 v10, 4, v10
    v_lshl_add_u32 v2, v8, 8, v10
    v_add_u32 v10, 4, v8
    v_xor_b32 v10, v10, v9
    v_lshlrev_b32 v10, 4, v10
    v_lshl_add_u32 v3, v8, 8, v10
    v_add_u32 v10, 8, v8
    v_xor_b32 v10, v10, v9
    v_lshlrev_b32 v10, 4, v10
    v_lshl_add_u32 v4, v8, 8, v10
    v_add_u32 v10, 12, v8
    v_xor_b32 v10, v10, v9
    v_lshlrev_b32 v10, 4, v10
    v_lshl_add_u32 v5, v8, 8, v10
    v_lshlrev_b32 v6, 4, v0
    v_mov_b32 v7, 147456
    s_lshr_b32 s20, s18, 12
    s_lshl_b32 s21, s18, 20
    s_mov_b32 s10, 0x100000
    s_mov_b32 s11, 0x20000
    s_mov_b32 s14, 0x100000
    s_mov_b32 s15, 0x20000
    s_waitcnt lgkmcnt(0)
    s_add_u32 s8, s4, s21
    s_addc_u32 s9, s5, s20
    s_add_u32 s12, s6, s21
    s_addc_u32 s13, s7, s20
    s_mov_b32 s22, 0
    s_mov_b32 s23, 0
    s_add_u32 m0, s23, 0
    s_add_u32 s24, s22, 0
    buffer_load_dwordx4 v2, s[8:11], s24 offen offset:0 nt lds
    buffer_load_dwordx4 v3, s[8:11], s24 offen offset:1024 nt lds
    buffer_load_dwordx4 v4, s[8:11], s24 offen offset:2048 nt lds
    buffer_load_dwordx4 v5, s[8:11], s24 offen offset:3072 nt lds
    s_add_u32 m0, s23, 4096
    s_add_u32 s24, s22, 4096
    buffer_load_dwordx4 v2, s[8:11], s24 offen offset:0 nt lds
    buffer_load_dwordx4 v3, s[8:11], s24 offen offset:1024 nt lds
    buffer_load_dwordx4 v4, s[8:11], s24 offen offset:2048 nt lds
    buffer_load_dwordx4 v5, s[8:11], s24 offen offset:3072 nt lds
    s_add_u32 m0, s23, 8192
    s_add_u32 s24, s22, 0
    buffer_load_dwordx4 v6, s[12:15], s24 offen offset:0 nt lds
    buffer_load_dwordx4 v6, s[12:15], s24 offen offset:1024 nt lds
    buffer_load_dwordx4 v6, s[12:15], s24 offen offset:2048 nt lds
    buffer_load_dwordx4 v6, s[12:15], s24 offen offset:3072 nt lds
    s_add_u32 m0, s23, 12288
    s_add_u32 s24, s22, 4096
    buffer_load_dwordx4 v6, s[12:15], s24 offen offset:0 nt lds
    buffer_load_dwordx4 v6, s[12:15], s24 offen offset:1024 nt lds
    buffer_load_dwordx4 v6, s[12:15], s24 offen offset:2048 nt lds
    buffer_load_dwordx4 v6, s[12:15], s24 offen offset:3072 nt lds
    s_load_dwordx2 s[40:41], s[0:1], 96
    s_mul_i32 s44, s17, 65536
    s_mov_b32 s42, 65536
    s_mov_b32 s43, 0x20000
    s_barrier
    ds_read_b128 v[12:15], v7 offset:16
    s_waitcnt lgkmcnt(0)
    s_add_u32 s40, s40, s44
    s_addc_u32 s41, s41, 0
    s_mov_b32 s25, 1
    s_mov_b32 s22, 8192
    s_mov_b32 s23, 16384
L_ld_loop:
    s_waitcnt lgkmcnt(0)
    v_min3_u32 v9, v12, v13, v14
    v_readfirstlane_b32 s30, v15
    v_readfirstlane_b32 s26, v9
    s_nop 0
    s_add_u32 s26, s26, 8
    s_cmp_ge_u32 s26, s25
    s_cbranch_scc1 L_ld_free
    s_mov_b32 s27, 262144
L_ld_spin:
    s_sleep 1
    ds_read_b128 v[12:15], v7 offset:16
    s_waitcnt lgkmcnt(0)
    v_min3_u32 v9, v12, v13, v14
    s_nop 0
    v_readfirstlane_b32 s26, v9
    s_nop 0
    s_add_u32 s26, s26, 8
    s_cmp_ge_u32 s26, s25
    s_cbranch_scc1 L_ld_free
    s_sub_u32 s27, s27, 1
    s_cmp_lg_u32 s27, 0
    s_cbranch_scc1 L_ld_spin
L_ld_free:
    s_lshl_b32 s28, s25, 2
    s_mov_b32 s30, 0
    s_cmp_ge_u32 s25, 120
    s_cselect_b32 s30, 1, s30
    s_cmp_eq_u32 s30, 1
    s_cbranch_scc1 L_ld_body1
    s_waitcnt vmcnt(16)
    s_add_u32 m0, s23, 0
    s_add_u32 s24, s22, 0
    buffer_load_dwordx4 v2, s[8:11], s24 offen offset:0 nt lds
    buffer_load_dwordx4 v3, s[8:11], s24 offen offset:1024 nt lds
    buffer_load_dwordx4 v4, s[8:11], s24 offen offset:2048 nt lds
    buffer_load_dwordx4 v5, s[8:11], s24 offen offset:3072 nt lds
    s_add_i32 s29, s28, -4
    v_mov_b32 v8, s29
    ds_write_b32 v7, v8 offset:0
    s_waitcnt vmcnt(16)
    s_add_u32 m0, s23, 4096
    s_add_u32 s24, s22, 4096
    buffer_load_dwordx4 v2, s[8:11], s24 offen offset:0 nt lds
    buffer_load_dwordx4 v3, s[8:11], s24 offen offset:1024 nt lds
    buffer_load_dwordx4 v4, s[8:11], s24 offen offset:2048 nt lds
    buffer_load_dwordx4 v5, s[8:11], s24 offen offset:3072 nt lds
    s_add_i32 s29, s28, -3
    v_mov_b32 v8, s29
    ds_write_b32 v7, v8 offset:0
    s_waitcnt vmcnt(16)
    s_add_u32 m0, s23, 8192
    s_add_u32 s24, s22, 0
    buffer_load_dwordx4 v6, s[12:15], s24 offen offset:0 nt lds
    buffer_load_dwordx4 v6, s[12:15], s24 offen offset:1024 nt lds
    buffer_load_dwordx4 v6, s[12:15], s24 offen offset:2048 nt lds
    buffer_load_dwordx4 v6, s[12:15], s24 offen offset:3072 nt lds
    s_add_i32 s29, s28, -2
    v_mov_b32 v8, s29
    ds_write_b32 v7, v8 offset:0
    ds_read_b128 v[12:15], v7 offset:16
    s_waitcnt vmcnt(16)
    s_add_u32 m0, s23, 12288
    s_add_u32 s24, s22, 4096
    buffer_load_dwordx4 v6, s[12:15], s24 offen offset:0 nt lds
    buffer_load_dwordx4 v6, s[12:15], s24 offen offset:1024 nt lds
    buffer_load_dwordx4 v6, s[12:15], s24 offen offset:2048 nt lds
    buffer_load_dwordx4 v6, s[12:15], s24 offen offset:3072 nt lds
    s_add_i32 s29, s28, -1
    v_mov_b32 v8, s29
    ds_write_b32 v7, v8 offset:0
    s_branch L_ld_next
L_ld_body1:
    s_waitcnt vmcnt(28)
    s_add_u32 m0, s23, 0
    s_add_u32 s24, s22, 0
    buffer_load_dwordx4 v2, s[8:11], s24 offen offset:0 nt lds
    buffer_load_dwordx4 v3, s[8:11], s24 offen offset:1024 nt lds
    buffer_load_dwordx4 v4, s[8:11], s24 offen offset:2048 nt lds
    buffer_load_dwordx4 v5, s[8:11], s24 offen offset:3072 nt lds
    s_add_i32 s29, s28, -7
    v_mov_b32 v8, s29
    ds_write_b32 v7, v8 offset:0
    s_waitcnt vmcnt(28)
    s_add_u32 m0, s23, 4096
    s_add_u32 s24, s22, 4096
    buffer_load_dwordx4 v2, s[8:11], s24 offen offset:0 nt lds
    buffer_load_dwordx4 v3, s[8:11], s24 offen offset:1024 nt lds
    buffer_load_dwordx4 v4, s[8:11], s24 offen offset:2048 nt lds
    buffer_load_dwordx4 v5, s[8:11], s24 offen offset:3072 nt lds
    s_add_i32 s29, s28, -6
    v_mov_b32 v8, s29
    ds_write_b32 v7, v8 offset:0
    s_waitcnt vmcnt(28)
    s_add_u32 m0, s23, 8192
    s_add_u32 s24, s22, 0
    buffer_load_dwordx4 v6, s[12:15], s24 offen offset:0 nt lds
    buffer_load_dwordx4 v6, s[12:15], s24 offen offset:1024 nt lds
    buffer_load_dwordx4 v6, s[12:15], s24 offen offset:2048 nt lds
    buffer_load_dwordx4 v6, s[12:15], s24 offen offset:3072 nt lds
    s_add_i32 s29, s28, -5
    v_mov_b32 v8, s29
    ds_write_b32 v7, v8 offset:0
    ds_read_b128 v[12:15], v7 offset:16
    s_waitcnt vmcnt(28)
    s_add_u32 m0, s23, 12288
    s_add_u32 s24, s22, 4096
    buffer_load_dwordx4 v6, s[12:15], s24 offen offset:0 nt lds
    buffer_load_dwordx4 v6, s[12:15], s24 offen offset:1024 nt lds
    buffer_load_dwordx4 v6, s[12:15], s24 offen offset:2048 nt lds
    buffer_load_dwordx4 v6, s[12:15], s24 offen offset:3072 nt lds
    s_add_i32 s29, s28, -4
    v_mov_b32 v8, s29
    ds_write_b32 v7, v8 offset:0
L_ld_next:
    s_add_u32 s22, s22, 8192
    s_add_u32 s23, s23, 16384
    s_cmp_ge_u32 s23, 147456
    s_cselect_b32 s23, 0, s23
    s_add_u32 s25, s25, 1
    s_cmp_lt_u32 s25, 126
    s_cbranch_scc1 L_ld_loop
    s_mov_b32 s27, 262144
L_ld_spin2:
    ds_read_b128 v[12:15], v7 offset:16
    s_waitcnt lgkmcnt(0)
    v_min3_u32 v9, v12, v13, v14
    s_nop 0
    v_readfirstlane_b32 s26, v9
    s_nop 0
    s_cmp_ge_u32 s26, 119
    s_cbranch_scc1 L_ld_free2
    s_sub_u32 s27, s27, 1
    s_cmp_lg_u32 s27, 0
    s_cbranch_scc1 L_ld_spin2
L_ld_free2:
    s_add_u32 s32, s22, 8192
    s_add_u32 s33, s23, 16384
    s_cmp_ge_u32 s33, 147456
    s_cselect_b32 s33, 0, s33
    s_waitcnt vmcnt(28)
    s_add_u32 m0, s23, 0
    s_add_u32 s24, s22, 0
    buffer_load_dwordx4 v2, s[8:11], s24 offen offset:0 nt lds
    buffer_load_dwordx4 v3, s[8:11], s24 offen offset:1024 nt lds
    buffer_load_dwordx4 v4, s[8:11], s24 offen offset:2048 nt lds
    buffer_load_dwordx4 v5, s[8:11], s24 offen offset:3072 nt lds
    v_mov_b32 v8, 497
    ds_write_b32 v7, v8 offset:0
    s_waitcnt vmcnt(28)
    s_add_u32 m0, s23, 4096
    s_add_u32 s24, s22, 4096
    buffer_load_dwordx4 v2, s[8:11], s24 offen offset:0 nt lds
    buffer_load_dwordx4 v3, s[8:11], s24 offen offset:1024 nt lds
    buffer_load_dwordx4 v4, s[8:11], s24 offen offset:2048 nt lds
    buffer_load_dwordx4 v5, s[8:11], s24 offen offset:3072 nt lds
    v_mov_b32 v8, 498
    ds_write_b32 v7, v8 offset:0
    s_waitcnt vmcnt(28)
    s_add_u32 m0, s33, 0
    s_add_u32 s24, s32, 0
    buffer_load_dwordx4 v2, s[8:11], s24 offen offset:0 nt lds
    buffer_load_dwordx4 v3, s[8:11], s24 offen offset:1024 nt lds
    buffer_load_dwordx4 v4, s[8:11], s24 offen offset:2048 nt lds
    buffer_load_dwordx4 v5, s[8:11], s24 offen offset:3072 nt lds
    v_mov_b32 v8, 499
    ds_write_b32 v7, v8 offset:0
    s_waitcnt vmcnt(28)
    s_add_u32 m0, s33, 4096
    s_add_u32 s24, s32, 4096
    buffer_load_dwordx4 v2, s[8:11], s24 offen offset:0 nt lds
    buffer_load_dwordx4 v3, s[8:11], s24 offen offset:1024 nt lds
    buffer_load_dwordx4 v4, s[8:11], s24 offen offset:2048 nt lds
    buffer_load_dwordx4 v5, s[8:11], s24 offen offset:3072 nt lds
    v_mov_b32 v8, 500
    ds_write_b32 v7, v8 offset:0
    s_waitcnt vmcnt(28)
    s_add_u32 m0, s23, 8192
    s_add_u32 s24, s22, 0
    buffer_load_dwordx4 v6, s[12:15], s24 offen offset:0 nt lds
    buffer_load_dwordx4 v6, s[12:15], s24 offen offset:1024 nt lds
    buffer_load_dwordx4 v6, s[12:15], s24 offen offset:2048 nt lds
    buffer_load_dwordx4 v6, s[12:15], s24 offen offset:3072 nt lds
    v_mov_b32 v8, 501
    ds_write_b32 v7, v8 offset:0
    s_waitcnt vmcnt(28)
    s_add_u32 m0, s23, 12288
    s_add_u32 s24, s22, 4096
    buffer_load_dwordx4 v6, s[12:15], s24 offen offset:0 nt lds
    buffer_load_dwordx4 v6, s[12:15], s24 offen offset:1024 nt lds
    buffer_load_dwordx4 v6, s[12:15], s24 offen offset:2048 nt lds
    buffer_load_dwordx4 v6, s[12:15], s24 offen offset:3072 nt lds
    v_mov_b32 v8, 502
    ds_write_b32 v7, v8 offset:0
    s_waitcnt vmcnt(28)
    s_add_u32 m0, s33, 8192
    s_add_u32 s24, s32, 0
    buffer_load_dwordx4 v6, s[12:15], s24 offen offset:0 nt lds
    buffer_load_dwordx4 v6, s[12:15], s24 offen offset:1024 nt lds
    buffer_load_dwordx4 v6, s[12:15], s24 offen offset:2048 nt lds
    buffer_load_dwordx4 v6, s[12:15], s24 offen offset:3072 nt lds
    v_mov_b32 v8, 503
    ds_write_b32 v7, v8 offset:0
    s_waitcnt vmcnt(28)
    s_add_u32 m0, s33, 12288
    s_add_u32 s24, s32, 4096
    buffer_load_dwordx4 v6, s[12:15], s24 offen offset:0 nt lds
    buffer_load_dwordx4 v6, s[12:15], s24 offen offset:1024 nt lds
    buffer_load_dwordx4 v6, s[12:15], s24 offen offset:2048 nt lds
    buffer_load_dwordx4 v6, s[12:15], s24 offen offset:3072 nt lds
    v_mov_b32 v8, 504
    ds_write_b32 v7, v8 offset:0
    s_waitcnt vmcnt(28)
    v_mov_b32 v8, 505
    ds_write_b32 v7, v8 offset:0
    s_waitcnt vmcnt(24)
    v_mov_b32 v8, 506
    ds_write_b32 v7, v8 offset:0
    s_waitcnt vmcnt(20)
    v_mov_b32 v8, 507
    ds_write_b32 v7, v8 offset:0
    s_waitcnt vmcnt(16)
    v_mov_b32 v8, 508
    ds_write_b32 v7, v8 offset:0
    s_waitcnt vmcnt(12)
    v_mov_b32 v8, 509
    ds_write_b32 v7, v8 offset:0
    s_waitcnt vmcnt(8)
    v_mov_b32 v8, 510
    ds_write_b32 v7, v8 offset:0
    s_waitcnt vmcnt(4)
    v_mov_b32 v8, 511
    ds_write_b32 v7, v8 offset:0
    s_waitcnt vmcnt(0)
    v_mov_b32 v8, 512
    ds_write_b32 v7, v8 offset:0
    s_setprio 0
    s_branch L_join
L_notloader:
    s_cmp_ge_u32 s19, 4
    s_cbranch_scc1 L_side
    s_sub_u32 s20, s19, 1
    s_setprio 2
    v_mov_b32 v159, 147456
    v_and_b32 v157, 15, v0
    v_and_b32 v158, 1, v0
    v_sub_u32 v158, 0, v158
    v_xor_b32 v158, 0xffff, v158
    v_lshrrev_b32 v157, 1, v157
    v_cmp_eq_u32 vcc, 0, v157
    s_nop 1
    v_cndmask_b32 v140, 0, v158, vcc
    v_cmp_eq_u32 vcc, 1, v157
    s_nop 1
    v_cndmask_b32 v141, 0, v158, vcc
    v_cmp_eq_u32 vcc, 2, v157
    s_nop 1
    v_cndmask_b32 v142, 0, v158, vcc
    v_cmp_eq_u32 vcc, 3, v157
    s_nop 1
    v_cndmask_b32 v143, 0, v158, vcc
    v_lshrrev_b32 v1, 4, v0
    v_and_b32 v2, 15, v0
    v_add_u32 v3, 0, v1
    v_xor_b32 v3, v3, v2
    v_lshlrev_b32 v3, 4, v3
    v_lshl_add_u32 v144, v2, 8, v3
    v_add_u32 v3, 4, v1
    v_xor_b32 v3, v3, v2
    v_lshlrev_b32 v3, 4, v3
    v_lshl_add_u32 v145, v2, 8, v3
    v_add_u32 v3, 8, v1
    v_xor_b32 v3, v3, v2
    v_lshlrev_b32 v3, 4, v3
    v_lshl_add_u32 v146, v2, 8, v3
    v_add_u32 v3, 12, v1
    v_xor_b32 v3, v3, v2
    v_lshlrev_b32 v3, 4, v3
    v_lshl_add_u32 v147, v2, 8, v3
    v_lshlrev_b32 v3, 4, v2
    v_lshl_add_u32 v152, v1, 10, v3
    v_lshl_add_u32 v4, v1, 4, v159
    v_mov_b32 v154, 0xff7fffff
    v_mov_b32 v155, 0
    v_mov_b32 v136, 0
    v_mov_b32 v137, 0
    v_mov_b32 v138, 0
    v_mov_b32 v139, 0
    s_mov_b32 s21, 0x3e0293ee
    s_load_dwordx2 s[40:41], s[0:1], 96
    s_mul_i32 s44, s17, 65536
    s_mov_b32 s42, 65536
    s_mov_b32 s43, 0x20000
    s_waitcnt lgkmcnt(0)
    s_add_u32 s40, s40, s44
    s_addc_u32 s41, s41, 0
    s_barrier
    s_mov_b32 s22, s20
    s_lshl_b32 s23, s20, 14
    s_mov_b32 s28, -1
    s_lshl_b32 s24, s22, 2
    v_add_u32 v148, s23, v144
    v_add_u32 v149, s23, v145
    v_add_u32 v150, s23, v146
    v_add_u32 v151, s23, v147
    v_add_u32 v153, s23, v152
    s_add_u32 s24, s24, 4
    s_cmp_ge_i32 s28, s24
    s_cbranch_scc1 L_c_first0
    s_mov_b32 s27, 262144
L_spin_1:
    ds_read_b32 v157, v159 offset:0
    s_waitcnt lgkmcnt(0)
    v_readfirstlane_b32 s28, v157
    s_nop 0
    s_cmp_ge_i32 s28, s24
    s_cbranch_scc1 L_spun_2
    s_sleep 2
    s_sub_u32 s27, s27, 1
    s_cmp_lg_u32 s27, 0
    s_cbranch_scc1 L_spin_1
L_spun_2:
L_c_first0:
    ds_read_b128 v[32:35], v148 offset:0
    ds_read_b128 v[36:39], v149 offset:0
    ds_read_b128 v[40:43], v150 offset:0
    ds_read_b128 v[44:47], v151 offset:0
    ds_read_b128 v[48:51], v148 offset:4096
    ds_read_b128 v[52:55], v149 offset:4096
    ds_read_b128 v[56:59], v150 offset:4096
    ds_read_b128 v[60:63], v151 offset:4096
    s_waitcnt lgkmcnt(0)
    ds_read_b128 v[64:67], v153 offset:8192
    ds_read_b128 v[68:71], v153 offset:8448
    ds_read_b128 v[72:75], v153 offset:8704
    ds_read_b128 v[76:79], v153 offset:8960
    ds_read_b128 v[80:83], v153 offset:12288
    ds_read_b128 v[84:87], v153 offset:12544
    ds_read_b128 v[88:91], v153 offset:12800
    ds_read_b128 v[92:95], v153 offset:13056
    s_add_u32 s22, s22, 3
    v_mov_b32 v157, s22
    s_lshl_b32 s30, s20, 2
    v_add_u32 v158, s30, v159
    s_add_u32 s23, s23, 49152
    s_sub_u32 s30, s23, 147456
    s_cmp_ge_u32 s23, 147456
    s_cselect_b32 s23, s30, s23
    s_waitcnt lgkmcnt(0)
    ds_write_b32 v158, v157 offset:16
    s_mov_b32 s27, 262144
L_spin_3:
    ds_read_b32 v157, v159 offset:36
    s_waitcnt lgkmcnt(0)
    v_readfirstlane_b32 s26, v157
    s_nop 0
    s_cmp_ge_i32 s26, 1
    s_cbranch_scc1 L_spun_4
    s_sleep 2
    s_sub_u32 s27, s27, 1
    s_cmp_lg_u32 s27, 0
    s_cbranch_scc1 L_spin_3
L_spun_4:
    ds_read_b128 v[16:19], v4 offset:2304
    ds_read_b128 v[20:23], v4 offset:2368
    ds_read_b128 v[24:27], v4 offset:2432
    ds_read_b128 v[28:31], v4 offset:2496
    s_waitcnt lgkmcnt(0)
    v_mfma_f32_16x16x32_bf16 v[128:131], v[32:35], v[16:19], 0
    v_mfma_f32_16x16x32_bf16 v[128:131], v[36:39], v[20:23], v[128:131]
    v_mfma_f32_16x16x32_bf16 v[128:131], v[40:43], v[24:27], v[128:131]
    v_mfma_f32_16x16x32_bf16 v[128:131], v[44:47], v[28:31], v[128:131]
    v_mfma_f32_16x16x32_bf16 v[132:135], v[48:51], v[16:19], 0
    v_mfma_f32_16x16x32_bf16 v[132:135], v[52:55], v[20:23], v[132:135]
    v_mfma_f32_16x16x32_bf16 v[132:135], v[56:59], v[24:27], v[132:135]
    v_mfma_f32_16x16x32_bf16 v[132:135], v[60:63], v[28:31], v[132:135]
    s_nop 3
    v_max3_f32 v157, v128, v129, v130
    s_nop 2
    v_max3_f32 v158, v131, v132, v133
    v_max3_f32 v157, v157, v134, v135
    v_max_f32 v157, v157, v158
    v_mul_f32 v157, s21, v157
    v_max_f32 v157, v157, v154
    s_nop 1
    v_max_f32_dpp v157, v157, v157 row_bcast:15 row_mask:0xa bank_mask:0xf
    s_nop 1
    v_max_f32_dpp v157, v157, v157 row_bcast:31 row_mask:0xc bank_mask:0xf
    s_nop 0
    v_readlane_b32 s29, v157, 63
    s_nop 1
    v_subrev_f32 v156, s29, v154
    v_mov_b32 v154, s29
    v_exp_f32 v156, v156
    v_fma_f32 v128, v128, s21, -v154
    v_fma_f32 v129, v129, s21, -v154
    v_fma_f32 v130, v130, s21, -v154
    v_fma_f32 v131, v131, s21, -v154
    v_fma_f32 v132, v132, s21, -v154
    v_fma_f32 v133, v133, s21, -v154
    v_fma_f32 v134, v134, s21, -v154
    v_fma_f32 v135, v135, s21, -v154
    v_exp_f32 v128, v128
    v_exp_f32 v129, v129
    v_exp_f32 v130, v130
    v_exp_f32 v131, v131
    v_exp_f32 v132, v132
    v_exp_f32 v133, v133
    v_exp_f32 v134, v134
    v_exp_f32 v135, v135
    v_mul_f32 v155, v155, v156
    v_mul_f32 v136, v136, v156
    v_mul_f32 v137, v137, v156
    v_mul_f32 v138, v138, v156
    v_mul_f32 v139, v139, v156
    v_cvt_pk_bf16_f32 v158, v128, v128
    v_add_f32 v155, v155, v128
    v_and_b32 v96, v158, v140
    v_and_b32 v97, v158, v141
    v_and_b32 v98, v158, v142
    v_and_b32 v99, v158, v143
    v_cvt_pk_bf16_f32 v158, v129, v129
    v_add_f32 v155, v155, v129
    v_and_b32 v100, v158, v140
    v_and_b32 v101, v158, v141
    v_and_b32 v102, v158, v142
    v_and_b32 v103, v158, v143
    v_cvt_pk_bf16_f32 v158, v130, v130
    v_add_f32 v155, v155, v130
    v_and_b32 v104, v158, v140
    v_and_b32 v105, v158, v141
    v_and_b32 v106, v158, v142
    v_and_b32 v107, v158, v143
    v_cvt_pk_bf16_f32 v158, v131, v131
    v_add_f32 v155, v155, v131
    v_and_b32 v108, v158, v140
    v_and_b32 v109, v158, v141
    v_and_b32 v110, v158, v142
    v_and_b32 v111, v158, v143
    v_cvt_pk_bf16_f32 v158, v132, v132
    v_add_f32 v155, v155, v132
    v_and_b32 v112, v158, v140
    v_and_b32 v113, v158, v141
    v_and_b32 v114, v158, v142
    v_and_b32 v115, v158, v143
    v_cvt_pk_bf16_f32 v158, v133, v133
    v_add_f32 v155, v155, v133
    v_and_b32 v116, v158, v140
    v_and_b32 v117, v158, v141
    v_and_b32 v118, v158, v142
    v_and_b32 v119, v158, v143
    v_cvt_pk_bf16_f32 v158, v134, v134
    v_add_f32 v155, v155, v134
    v_and_b32 v120, v158, v140
    v_and_b32 v121, v158, v141
    v_and_b32 v122, v158, v142
    v_and_b32 v123, v158, v143
    v_cvt_pk_bf16_f32 v158, v135, v135
    v_add_f32 v155, v155, v135
    v_and_b32 v124, v158, v140
    v_and_b32 v125, v158, v141
    v_and_b32 v126, v158, v142
    v_and_b32 v127, v158, v143
    v_mfma_f32_16x16x32_bf16 v[136:139], v[96:99], v[64:67], v[136:139]
    v_mfma_f32_16x16x32_bf16 v[136:139], v[100:103], v[68:71], v[136:139]
    v_mfma_f32_16x16x32_bf16 v[136:139], v[104:107], v[72:75], v[136:139]
    v_mfma_f32_16x16x32_bf16 v[136:139], v[108:111], v[76:79], v[136:139]
    v_mfma_f32_16x16x32_bf16 v[136:139], v[112:115], v[80:83], v[136:139]
    v_mfma_f32_16x16x32_bf16 v[136:139], v[116:119], v[84:87], v[136:139]
    v_mfma_f32_16x16x32_bf16 v[136:139], v[120:123], v[88:91], v[136:139]
    v_mfma_f32_16x16x32_bf16 v[136:139], v[124:127], v[92:95], v[136:139]
L_c_loop:
    s_lshl_b32 s24, s22, 2
    v_add_u32 v148, s23, v144
    v_add_u32 v149, s23, v145
    v_add_u32 v150, s23, v146
    v_add_u32 v151, s23, v147
    v_add_u32 v153, s23, v152
    s_add_u32 s24, s24, 2
    s_cmp_eq_u32 s22, 127
    s_cselect_b32 s30, 2, 0
    s_sub_u32 s24, s24, s30
    s_cmp_ge_i32 s28, s24
    s_cbranch_scc1 L_c_kok
    s_mov_b32 s27, 262144
L_spin_5:
    ds_read_b32 v157, v159 offset:0
    s_waitcnt lgkmcnt(0)
    v_readfirstlane_b32 s28, v157
    s_nop 0
    s_cmp_ge_i32 s28, s24
    s_cbranch_scc1 L_spun_6
    s_sleep 2
    s_sub_u32 s27, s27, 1
    s_cmp_lg_u32 s27, 0
    s_cbranch_scc1 L_spin_5
L_spun_6:
L_c_kok:
    ds_read_b128 v[32:35], v148 offset:0
    ds_read_b128 v[36:39], v149 offset:0
    ds_read_b128 v[40:43], v150 offset:0
    ds_read_b128 v[44:47], v151 offset:0
    ds_read_b128 v[48:51], v148 offset:4096
    ds_read_b128 v[52:55], v149 offset:4096
    ds_read_b128 v[56:59], v150 offset:4096
    ds_read_b128 v[60:63], v151 offset:4096
    s_waitcnt lgkmcnt(7)
    v_mfma_f32_16x16x32_bf16 v[128:131], v[32:35], v[16:19], 0
    s_waitcnt lgkmcnt(6)
    v_mfma_f32_16x16x32_bf16 v[128:131], v[36:39], v[20:23], v[128:131]
    s_waitcnt lgkmcnt(5)
    v_mfma_f32_16x16x32_bf16 v[128:131], v[40:43], v[24:27], v[128:131]
    s_waitcnt lgkmcnt(4)
    v_mfma_f32_16x16x32_bf16 v[128:131], v[44:47], v[28:31], v[128:131]
    s_waitcnt lgkmcnt(3)
    v_mfma_f32_16x16x32_bf16 v[132:135], v[48:51], v[16:19], 0
    s_waitcnt lgkmcnt(2)
    v_mfma_f32_16x16x32_bf16 v[132:135], v[52:55], v[20:23], v[132:135]
    s_waitcnt lgkmcnt(1)
    v_mfma_f32_16x16x32_bf16 v[132:135], v[56:59], v[24:27], v[132:135]
    s_waitcnt lgkmcnt(0)
    v_mfma_f32_16x16x32_bf16 v[132:135], v[60:63], v[28:31], v[132:135]
    s_lshl_b32 s24, s22, 2
    s_add_u32 s24, s24, 4
    s_cmp_eq_u32 s22, 126
    s_cselect_b32 s30, 2, 0
    s_add_u32 s24, s24, s30
    v_max3_f32 v157, v128, v129, v130
    s_nop 1
    v_max3_f32 v158, v131, v132, v133
    v_max3_f32 v157, v157, v134, v135
    v_max_f32 v157, v157, v158
    v_mul_f32 v157, s21, v157
    v_max_f32 v157, v157, v154
    s_nop 1
    v_max_f32_dpp v157, v157, v157 row_bcast:15 row_mask:0xa bank_mask:0xf
    s_nop 1
    v_max_f32_dpp v157, v157, v157 row_bcast:31 row_mask:0xc bank_mask:0xf
    s_nop 0
    v_readlane_b32 s29, v157, 63
    s_nop 1
    v_subrev_f32 v156, s29, v154
    v_mov_b32 v154, s29
    v_exp_f32 v156, v156
    v_fma_f32 v128, v128, s21, -v154
    v_fma_f32 v129, v129, s21, -v154
    v_fma_f32 v130, v130, s21, -v154
    v_fma_f32 v131, v131, s21, -v154
    v_fma_f32 v132, v132, s21, -v154
    v_fma_f32 v133, v133, s21, -v154
    v_fma_f32 v134, v134, s21, -v154
    v_fma_f32 v135, v135, s21, -v154
    v_exp_f32 v128, v128
    v_exp_f32 v129, v129
    v_exp_f32 v130, v130
    v_exp_f32 v131, v131
    v_exp_f32 v132, v132
    v_exp_f32 v133, v133
    v_exp_f32 v134, v134
    v_exp_f32 v135, v135
    v_mul_f32 v155, v155, v156
    v_mul_f32 v136, v136, v156
    v_mul_f32 v137, v137, v156
    v_mul_f32 v138, v138, v156
    v_mul_f32 v139, v139, v156
    v_cvt_pk_bf16_f32 v158, v128, v128
    v_add_f32 v155, v155, v128
    v_and_b32 v96, v158, v140
    v_and_b32 v97, v158, v141
    v_and_b32 v98, v158, v142
    v_and_b32 v99, v158, v143
    v_cvt_pk_bf16_f32 v158, v129, v129
    v_add_f32 v155, v155, v129
    v_and_b32 v100, v158, v140
    v_and_b32 v101, v158, v141
    v_and_b32 v102, v158, v142
    v_and_b32 v103, v158, v143
    v_cvt_pk_bf16_f32 v158, v130, v130
    v_add_f32 v155, v155, v130
    v_and_b32 v104, v158, v140
    v_and_b32 v105, v158, v141
    v_and_b32 v106, v158, v142
    v_and_b32 v107, v158, v143
    v_cvt_pk_bf16_f32 v158, v131, v131
    v_add_f32 v155, v155, v131
    v_and_b32 v108, v158, v140
    v_and_b32 v109, v158, v141
    v_and_b32 v110, v158, v142
    v_and_b32 v111, v158, v143
    v_cvt_pk_bf16_f32 v158, v132, v132
    v_add_f32 v155, v155, v132
    v_and_b32 v112, v158, v140
    v_and_b32 v113, v158, v141
    v_and_b32 v114, v158, v142
    v_and_b32 v115, v158, v143
    v_cvt_pk_bf16_f32 v158, v133, v133
    v_add_f32 v155, v155, v133
    v_and_b32 v116, v158, v140
    v_and_b32 v117, v158, v141
    v_and_b32 v118, v158, v142
    v_and_b32 v119, v158, v143
    v_cvt_pk_bf16_f32 v158, v134, v134
    v_add_f32 v155, v155, v134
    v_and_b32 v120, v158, v140
    v_and_b32 v121, v158, v141
    v_and_b32 v122, v158, v142
    v_and_b32 v123, v158, v143
    v_cvt_pk_bf16_f32 v158, v135, v135
    v_add_f32 v155, v155, v135
    v_and_b32 v124, v158, v140
    v_and_b32 v125, v158, v141
    v_and_b32 v126, v158, v142
    v_and_b32 v127, v158, v143
    s_add_u32 s30, s22, 3
    s_cmp_lt_u32 s30, 128
    s_cbranch_scc1 L_c_notlast
    v_add_f32_dpp v155, v155, v155 row_bcast:15 row_mask:0xa bank_mask:0xf
    s_nop 1
    v_add_f32_dpp v155, v155, v155 row_bcast:31 row_mask:0xc bank_mask:0xf
    s_nop 0
    v_readlane_b32 s29, v155, 63
    s_lshl_b32 s30, s20, 10
    v_lshrrev_b32 v1, 4, v0
    v_and_b32 v2, 15, v0
    v_lshlrev_b32 v1, 4, v1
    v_lshl_add_u32 v1, v2, 5, v1
    v_add_u32 v1, s30, v1
    v_add_u32 v1, v1, v159
    v_add_u32 v2, s30, v159
    v_mov_b32 v155, s29
    v_mov_b32 v3, 1
    s_mov_b64 exec, 1
    ds_write_b64 v2, v[154:155] offset:5120
    s_waitcnt lgkmcnt(0)
    ds_add_u32 v159, v3 offset:48
    s_mov_b64 exec, -1
    s_mov_b32 s27, 262144
L_spin_7:
    ds_read_b32 v157, v159 offset:0
    s_waitcnt lgkmcnt(0)
    v_readfirstlane_b32 s28, v157
    s_nop 0
    s_cmp_ge_i32 s28, s24
    s_cbranch_scc1 L_spun_8
    s_sub_u32 s27, s27, 1
    s_cmp_lg_u32 s27, 0
    s_cbranch_scc1 L_spin_7
L_spun_8:
L_c_notlast:
    s_cmp_ge_i32 s28, s24
    s_cbranch_scc1 L_c_vok
    s_mov_b32 s27, 262144
L_spin_9:
    ds_read_b32 v157, v159 offset:0
    s_waitcnt lgkmcnt(0)
    v_readfirstlane_b32 s28, v157
    s_nop 0
    s_cmp_ge_i32 s28, s24
    s_cbranch_scc1 L_spun_10
    s_sleep 2
    s_sub_u32 s27, s27, 1
    s_cmp_lg_u32 s27, 0
    s_cbranch_scc1 L_spin_9
L_spun_10:
L_c_vok:
    ds_read_b128 v[64:67], v153 offset:8192
    ds_read_b128 v[68:71], v153 offset:8448
    ds_read_b128 v[72:75], v153 offset:8704
    ds_read_b128 v[76:79], v153 offset:8960
    ds_read_b128 v[80:83], v153 offset:12288
    ds_read_b128 v[84:87], v153 offset:12544
    ds_read_b128 v[88:91], v153 offset:12800
    ds_read_b128 v[92:95], v153 offset:13056
    s_add_u32 s22, s22, 3
    v_mov_b32 v157, s22
    s_lshl_b32 s30, s20, 2
    v_add_u32 v158, s30, v159
    s_add_u32 s23, s23, 49152
    s_sub_u32 s30, s23, 147456
    s_cmp_ge_u32 s23, 147456
    s_cselect_b32 s23, s30, s23
    s_waitcnt lgkmcnt(7)
    v_mfma_f32_16x16x32_bf16 v[136:139], v[96:99], v[64:67], v[136:139]
    s_waitcnt lgkmcnt(6)
    v_mfma_f32_16x16x32_bf16 v[136:139], v[100:103], v[68:71], v[136:139]
    s_waitcnt lgkmcnt(5)
    v_mfma_f32_16x16x32_bf16 v[136:139], v[104:107], v[72:75], v[136:139]
    s_waitcnt lgkmcnt(4)
    v_mfma_f32_16x16x32_bf16 v[136:139], v[108:111], v[76:79], v[136:139]
    s_waitcnt lgkmcnt(3)
    v_mfma_f32_16x16x32_bf16 v[136:139], v[112:115], v[80:83], v[136:139]
    s_waitcnt lgkmcnt(2)
    v_mfma_f32_16x16x32_bf16 v[136:139], v[116:119], v[84:87], v[136:139]
    s_waitcnt lgkmcnt(1)
    v_mfma_f32_16x16x32_bf16 v[136:139], v[120:123], v[88:91], v[136:139]
    s_waitcnt lgkmcnt(0)
    ds_write_b32 v158, v157 offset:16
    v_mfma_f32_16x16x32_bf16 v[136:139], v[124:127], v[92:95], v[136:139]
    s_cmp_lt_u32 s22, 128
    s_cbranch_scc1 L_c_loop
    s_mov_b32 exec_hi, 0
    s_nop 4
    ds_write_b128 v1, v[136:139] offset:4608
    s_mov_b64 exec, -1
    s_branch L_join
L_side:
    s_sub_u32 s20, s19, 4
    s_mov_b32 s70, 256
    s_mov_b32 s71, 0x20000
    s_load_dwordx2 s[44:45], s[0:1], 0
    s_load_dwordx4 s[24:27], s[0:1], 24
    s_load_dwordx4 s[28:31], s[0:1], 48
    s_load_dwordx4 s[32:35], s[0:1], 64
    v_mov_b32 v228, 147456
    v_lshrrev_b32 v1, 4, v0
    v_and_b32 v2, 15, v0
    s_cmp_lg_u32 s20, 0
    s_cbranch_scc1 L_s_noinit
    v_mov_b32 v8, 0
    v_mov_b32 v9, 0
    v_mov_b32 v10, 0
    v_mov_b32 v11, 0
    ds_write_b128 v228, v[8:11] offset:0
    ds_write_b128 v228, v[8:11] offset:32
    ds_write_b128 v228, v[8:11] offset:48
    v_mov_b32 v9, 1
    v_mov_b32 v10, 2
    v_mov_b32 v11, 0
    ds_write_b128 v228, v[8:11] offset:16
L_s_noinit:
    v_lshlrev_b32 v3, 3, v1
    v_lshlrev_b32 v224, 15, v1
    v_lshl_add_u32 v224, v2, 4, v224
    s_lshl_b32 s46, s17, 2
    s_add_u32 s46, s46, s20
    s_add_u32 s21, s46, 0
    s_sub_u32 s22, s21, 40
    s_cmp_ge_u32 s21, 40
    s_cselect_b32 s50, s22, s21
    s_add_u32 s21, s46, 4
    s_sub_u32 s22, s21, 40
    s_cmp_ge_u32 s21, 40
    s_cselect_b32 s51, s22, s21
    s_add_u32 s21, s46, 8
    s_sub_u32 s22, s21, 40
    s_cmp_ge_u32 s21, 40
    s_cselect_b32 s52, s22, s21
    s_add_u32 s21, s46, 12
    s_sub_u32 s22, s21, 40
    s_cmp_ge_u32 s21, 40
    s_cselect_b32 s53, s22, s21
    s_add_u32 s21, s46, 16
    s_sub_u32 s22, s21, 40
    s_cmp_ge_u32 s21, 40
    s_cselect_b32 s54, s22, s21
    s_add_u32 s21, s46, 20
    s_sub_u32 s22, s21, 40
    s_cmp_ge_u32 s21, 40
    s_cselect_b32 s55, s22, s21
    s_add_u32 s21, s46, 24
    s_sub_u32 s22, s21, 40
    s_cmp_ge_u32 s21, 40
    s_cselect_b32 s56, s22, s21
    s_add_u32 s21, s46, 28
    s_sub_u32 s22, s21, 40
    s_cmp_ge_u32 s21, 40
    s_cselect_b32 s57, s22, s21
    s_add_u32 s21, s46, 32
    s_sub_u32 s22, s21, 40
    s_cmp_ge_u32 s21, 40
    s_cselect_b32 s58, s22, s21
    s_add_u32 s21, s46, 36
    s_sub_u32 s22, s21, 40
    s_cmp_ge_u32 s21, 40
    s_cselect_b32 s59, s22, s21
    s_waitcnt lgkmcnt(0)
    s_mul_i32 s21, s17, 1280
    s_add_u32 s4, s44, s21
    s_addc_u32 s5, s45, 0
    s_mov_b32 s6, 1280
    s_mov_b32 s7, 0x20000
    s_lshl_b32 s21, s16, 8
    s_add_u32 s8, s24, s21
    s_addc_u32 s9, s25, 0
    s_sub_u32 s10, 5242880, s21
    s_mov_b32 s11, 0x20000
    s_lshl_b32 s21, s50, 5
    buffer_load_dwordx2 v[32:33], v3, s[4:7], s21 offen
    s_lshl_b32 s21, s51, 5
    buffer_load_dwordx2 v[34:35], v3, s[4:7], s21 offen
    s_lshl_b32 s21, s52, 5
    buffer_load_dwordx2 v[36:37], v3, s[4:7], s21 offen
    s_lshl_b32 s21, s53, 5
    buffer_load_dwordx2 v[38:39], v3, s[4:7], s21 offen
    s_lshl_b32 s21, s54, 5
    buffer_load_dwordx2 v[40:41], v3, s[4:7], s21 offen
    s_lshl_b32 s21, s55, 5
    buffer_load_dwordx2 v[42:43], v3, s[4:7], s21 offen
    s_lshl_b32 s21, s56, 5
    buffer_load_dwordx2 v[44:45], v3, s[4:7], s21 offen
    s_lshl_b32 s21, s57, 5
    buffer_load_dwordx2 v[46:47], v3, s[4:7], s21 offen
    s_lshl_b32 s21, s58, 5
    buffer_load_dwordx2 v[48:49], v3, s[4:7], s21 offen
    s_lshl_b32 s21, s59, 5
    buffer_load_dwordx2 v[50:51], v3, s[4:7], s21 offen
    s_lshl_b32 s21, s50, 17
    buffer_load_dwordx4 v[64:67], v224, s[8:11], s21 offen nt
    s_lshl_b32 s21, s50, 17
    s_add_u32 s21, s21, 8192
    buffer_load_dwordx4 v[68:71], v224, s[8:11], s21 offen nt
    s_lshl_b32 s21, s50, 17
    s_add_u32 s21, s21, 16384
    buffer_load_dwordx4 v[72:75], v224, s[8:11], s21 offen nt
    s_lshl_b32 s21, s50, 17
    s_add_u32 s21, s21, 24576
    buffer_load_dwordx4 v[76:79], v224, s[8:11], s21 offen nt
    s_lshl_b32 s21, s51, 17
    buffer_load_dwordx4 v[80:83], v224, s[8:11], s21 offen nt
    s_lshl_b32 s21, s51, 17
    s_add_u32 s21, s21, 8192
    buffer_load_dwordx4 v[84:87], v224, s[8:11], s21 offen nt
    s_lshl_b32 s21, s51, 17
    s_add_u32 s21, s21, 16384
    buffer_load_dwordx4 v[88:91], v224, s[8:11], s21 offen nt
    s_lshl_b32 s21, s51, 17
    s_add_u32 s21, s21, 24576
    buffer_load_dwordx4 v[92:95], v224, s[8:11], s21 offen nt
    s_lshl_b32 s21, s52, 17
    buffer_load_dwordx4 v[96:99], v224, s[8:11], s21 offen nt
    s_lshl_b32 s21, s52, 17
    s_add_u32 s21, s21, 8192
    buffer_load_dwordx4 v[100:103], v224, s[8:11], s21 offen nt
    s_lshl_b32 s21, s52, 17
    s_add_u32 s21, s21, 16384
    buffer_load_dwordx4 v[104:107], v224, s[8:11], s21 offen nt
    s_lshl_b32 s21, s52, 17
    s_add_u32 s21, s21, 24576
    buffer_load_dwordx4 v[108:111], v224, s[8:11], s21 offen nt
    s_lshl_b32 s21, s53, 17
    buffer_load_dwordx4 v[112:115], v224, s[8:11], s21 offen nt
    s_lshl_b32 s21, s53, 17
    s_add_u32 s21, s21, 8192
    buffer_load_dwordx4 v[116:119], v224, s[8:11], s21 offen nt
    s_lshl_b32 s21, s53, 17
    s_add_u32 s21, s21, 16384
    buffer_load_dwordx4 v[120:123], v224, s[8:11], s21 offen nt
    s_lshl_b32 s21, s53, 17
    s_add_u32 s21, s21, 24576
    buffer_load_dwordx4 v[124:127], v224, s[8:11], s21 offen nt
    s_lshl_b32 s21, s54, 17
    buffer_load_dwordx4 v[128:131], v224, s[8:11], s21 offen nt
    s_lshl_b32 s21, s54, 17
    s_add_u32 s21, s21, 8192
    buffer_load_dwordx4 v[132:135], v224, s[8:11], s21 offen nt
    s_lshl_b32 s21, s54, 17
    s_add_u32 s21, s21, 16384
    buffer_load_dwordx4 v[136:139], v224, s[8:11], s21 offen nt
    s_lshl_b32 s21, s54, 17
    s_add_u32 s21, s21, 24576
    buffer_load_dwordx4 v[140:143], v224, s[8:11], s21 offen nt
    s_barrier
    v_and_b32 v225, 15, v0
    v_and_b32 v226, 1, v0
    v_sub_u32 v226, 0, v226
    v_xor_b32 v226, 0xffff, v226
    v_lshrrev_b32 v225, 1, v225
    v_cmp_eq_u32 vcc, 0, v225
    s_nop 1
    v_cndmask_b32 v4, 0, v226, vcc
    v_cmp_eq_u32 vcc, 1, v225
    s_nop 1
    v_cndmask_b32 v5, 0, v226, vcc
    v_cmp_eq_u32 vcc, 2, v225
    s_nop 1
    v_cndmask_b32 v6, 0, v226, vcc
    v_cmp_eq_u32 vcc, 3, v225
    s_nop 1
    v_cndmask_b32 v7, 0, v226, vcc
    s_mov_b32 s36, 0x01000100
    s_mov_b32 s37, 0x03020302
    s_waitcnt vmcnt(20)
    v_perm_b32 v225, v32, v32, s36
    v_and_b32 v8, v225, v4
    v_and_b32 v9, v225, v5
    v_and_b32 v10, v225, v6
    v_and_b32 v11, v225, v7
    s_waitcnt vmcnt(19)
    s_lshl_b32 s21, s55, 17
    buffer_load_dwordx4 v[144:147], v224, s[8:11], s21 offen nt
    v_mfma_f32_16x16x32_bf16 v[56:59], v[8:11], v[64:67], 0
    v_perm_b32 v225, v32, v32, s37
    v_and_b32 v52, v225, v4
    v_and_b32 v53, v225, v5
    v_and_b32 v54, v225, v6
    v_and_b32 v55, v225, v7
    s_waitcnt vmcnt(19)
    s_lshl_b32 s21, s55, 17
    s_add_u32 s21, s21, 8192
    buffer_load_dwordx4 v[148:151], v224, s[8:11], s21 offen nt
    v_mfma_f32_16x16x32_bf16 v[56:59], v[52:55], v[68:71], v[56:59]
    v_perm_b32 v225, v33, v33, s36
    v_and_b32 v8, v225, v4
    v_and_b32 v9, v225, v5
    v_and_b32 v10, v225, v6
    v_and_b32 v11, v225, v7
    s_waitcnt vmcnt(19)
    s_lshl_b32 s21, s55, 17
    s_add_u32 s21, s21, 16384
    buffer_load_dwordx4 v[152:155], v224, s[8:11], s21 offen nt
    v_mfma_f32_16x16x32_bf16 v[56:59], v[8:11], v[72:75], v[56:59]
    v_perm_b32 v225, v33, v33, s37
    v_and_b32 v52, v225, v4
    v_and_b32 v53, v225, v5
    v_and_b32 v54, v225, v6
    v_and_b32 v55, v225, v7
    s_waitcnt vmcnt(19)
    s_lshl_b32 s21, s55, 17
    s_add_u32 s21, s21, 24576
    buffer_load_dwordx4 v[156:159], v224, s[8:11], s21 offen nt
    v_mfma_f32_16x16x32_bf16 v[56:59], v[52:55], v[76:79], v[56:59]
    v_perm_b32 v225, v34, v34, s36
    v_and_b32 v8, v225, v4
    v_and_b32 v9, v225, v5
    v_and_b32 v10, v225, v6
    v_and_b32 v11, v225, v7
    s_waitcnt vmcnt(19)
    s_lshl_b32 s21, s56, 17
    buffer_load_dwordx4 v[160:163], v224, s[8:11], s21 offen nt
    v_mfma_f32_16x16x32_bf16 v[56:59], v[8:11], v[80:83], v[56:59]
    v_perm_b32 v225, v34, v34, s37
    v_and_b32 v52, v225, v4
    v_and_b32 v53, v225, v5
    v_and_b32 v54, v225, v6
    v_and_b32 v55, v225, v7
    s_waitcnt vmcnt(19)
    s_lshl_b32 s21, s56, 17
    s_add_u32 s21, s21, 8192
    buffer_load_dwordx4 v[164:167], v224, s[8:11], s21 offen nt
    v_mfma_f32_16x16x32_bf16 v[56:59], v[52:55], v[84:87], v[56:59]
    v_perm_b32 v225, v35, v35, s36
    v_and_b32 v8, v225, v4
    v_and_b32 v9, v225, v5
    v_and_b32 v10, v225, v6
    v_and_b32 v11, v225, v7
    s_waitcnt vmcnt(19)
    s_lshl_b32 s21, s56, 17
    s_add_u32 s21, s21, 16384
    buffer_load_dwordx4 v[168:171], v224, s[8:11], s21 offen nt
    v_mfma_f32_16x16x32_bf16 v[56:59], v[8:11], v[88:91], v[56:59]
    v_perm_b32 v225, v35, v35, s37
    v_and_b32 v52, v225, v4
    v_and_b32 v53, v225, v5
    v_and_b32 v54, v225, v6
    v_and_b32 v55, v225, v7
    s_waitcnt vmcnt(19)
    s_lshl_b32 s21, s56, 17
    s_add_u32 s21, s21, 24576
    buffer_load_dwordx4 v[172:175], v224, s[8:11], s21 offen nt
    v_mfma_f32_16x16x32_bf16 v[56:59], v[52:55], v[92:95], v[56:59]
    v_perm_b32 v225, v36, v36, s36
    v_and_b32 v8, v225, v4
    v_and_b32 v9, v225, v5
    v_and_b32 v10, v225, v6
    v_and_b32 v11, v225, v7
    s_waitcnt vmcnt(19)
    s_lshl_b32 s21, s57, 17
    buffer_load_dwordx4 v[176:179], v224, s[8:11], s21 offen nt
    v_mfma_f32_16x16x32_bf16 v[56:59], v[8:11], v[96:99], v[56:59]
    v_perm_b32 v225, v36, v36, s37
    v_and_b32 v52, v225, v4
    v_and_b32 v53, v225, v5
    v_and_b32 v54, v225, v6
    v_and_b32 v55, v225, v7
    s_waitcnt vmcnt(19)
    s_lshl_b32 s21, s57, 17
    s_add_u32 s21, s21, 8192
    buffer_load_dwordx4 v[180:183], v224, s[8:11], s21 offen nt
    v_mfma_f32_16x16x32_bf16 v[56:59], v[52:55], v[100:103], v[56:59]
    v_perm_b32 v225, v37, v37, s36
    v_and_b32 v8, v225, v4
    v_and_b32 v9, v225, v5
    v_and_b32 v10, v225, v6
    v_and_b32 v11, v225, v7
    s_waitcnt vmcnt(19)
    s_lshl_b32 s21, s57, 17
    s_add_u32 s21, s21, 16384
    buffer_load_dwordx4 v[184:187], v224, s[8:11], s21 offen nt
    v_mfma_f32_16x16x32_bf16 v[56:59], v[8:11], v[104:107], v[56:59]
    v_perm_b32 v225, v37, v37, s37
    v_and_b32 v52, v225, v4
    v_and_b32 v53, v225, v5
    v_and_b32 v54, v225, v6
    v_and_b32 v55, v225, v7
    s_waitcnt vmcnt(19)
    s_lshl_b32 s21, s57, 17
    s_add_u32 s21, s21, 24576
    buffer_load_dwordx4 v[188:191], v224, s[8:11], s21 offen nt
    v_mfma_f32_16x16x32_bf16 v[56:59], v[52:55], v[108:111], v[56:59]
    v_perm_b32 v225, v38, v38, s36
    v_and_b32 v8, v225, v4
    v_and_b32 v9, v225, v5
    v_and_b32 v10, v225, v6
    v_and_b32 v11, v225, v7
    s_waitcnt vmcnt(19)
    s_lshl_b32 s21, s58, 17
    buffer_load_dwordx4 v[192:195], v224, s[8:11], s21 offen nt
    v_mfma_f32_16x16x32_bf16 v[56:59], v[8:11], v[112:115], v[56:59]
    v_perm_b32 v225, v38, v38, s37
    v_and_b32 v52, v225, v4
    v_and_b32 v53, v225, v5
    v_and_b32 v54, v225, v6
    v_and_b32 v55, v225, v7
    s_waitcnt vmcnt(19)
    s_lshl_b32 s21, s58, 17
    s_add_u32 s21, s21, 8192
    buffer_load_dwordx4 v[196:199], v224, s[8:11], s21 offen nt
    v_mfma_f32_16x16x32_bf16 v[56:59], v[52:55], v[116:119], v[56:59]
    v_perm_b32 v225, v39, v39, s36
    v_and_b32 v8, v225, v4
    v_and_b32 v9, v225, v5
    v_and_b32 v10, v225, v6
    v_and_b32 v11, v225, v7
    s_waitcnt vmcnt(19)
    s_lshl_b32 s21, s58, 17
    s_add_u32 s21, s21, 16384
    buffer_load_dwordx4 v[200:203], v224, s[8:11], s21 offen nt
    v_mfma_f32_16x16x32_bf16 v[56:59], v[8:11], v[120:123], v[56:59]
    v_perm_b32 v225, v39, v39, s37
    v_and_b32 v52, v225, v4
    v_and_b32 v53, v225, v5
    v_and_b32 v54, v225, v6
    v_and_b32 v55, v225, v7
    s_waitcnt vmcnt(19)
    s_lshl_b32 s21, s58, 17
    s_add_u32 s21, s21, 24576
    buffer_load_dwordx4 v[204:207], v224, s[8:11], s21 offen nt
    v_mfma_f32_16x16x32_bf16 v[56:59], v[52:55], v[124:127], v[56:59]
    v_perm_b32 v225, v40, v40, s36
    v_and_b32 v8, v225, v4
    v_and_b32 v9, v225, v5
    v_and_b32 v10, v225, v6
    v_and_b32 v11, v225, v7
    s_waitcnt vmcnt(19)
    s_lshl_b32 s21, s59, 17
    buffer_load_dwordx4 v[208:211], v224, s[8:11], s21 offen nt
    v_mfma_f32_16x16x32_bf16 v[56:59], v[8:11], v[128:131], v[56:59]
    v_perm_b32 v225, v40, v40, s37
    v_and_b32 v52, v225, v4
    v_and_b32 v53, v225, v5
    v_and_b32 v54, v225, v6
    v_and_b32 v55, v225, v7
    s_waitcnt vmcnt(19)
    s_lshl_b32 s21, s59, 17
    s_add_u32 s21, s21, 8192
    buffer_load_dwordx4 v[212:215], v224, s[8:11], s21 offen nt
    v_mfma_f32_16x16x32_bf16 v[56:59], v[52:55], v[132:135], v[56:59]
    v_perm_b32 v225, v41, v41, s36
    v_and_b32 v8, v225, v4
    v_and_b32 v9, v225, v5
    v_and_b32 v10, v225, v6
    v_and_b32 v11, v225, v7
    s_waitcnt vmcnt(19)
    s_lshl_b32 s21, s59, 17
    s_add_u32 s21, s21, 16384
    buffer_load_dwordx4 v[216:219], v224, s[8:11], s21 offen nt
    v_mfma_f32_16x16x32_bf16 v[56:59], v[8:11], v[136:139], v[56:59]
    v_perm_b32 v225, v41, v41, s37
    v_and_b32 v52, v225, v4
    v_and_b32 v53, v225, v5
    v_and_b32 v54, v225, v6
    v_and_b32 v55, v225, v7
    s_waitcnt vmcnt(19)
    s_lshl_b32 s21, s59, 17
    s_add_u32 s21, s21, 24576
    buffer_load_dwordx4 v[220:223], v224, s[8:11], s21 offen nt
    v_mfma_f32_16x16x32_bf16 v[56:59], v[52:55], v[140:143], v[56:59]
    v_perm_b32 v225, v42, v42, s36
    v_and_b32 v8, v225, v4
    v_and_b32 v9, v225, v5
    v_and_b32 v10, v225, v6
    v_and_b32 v11, v225, v7
    s_waitcnt vmcnt(19)
    s_nop 0
    v_mfma_f32_16x16x32_bf16 v[56:59], v[8:11], v[144:147], v[56:59]
    v_perm_b32 v225, v42, v42, s37
    v_and_b32 v52, v225, v4
    v_and_b32 v53, v225, v5
    v_and_b32 v54, v225, v6
    v_and_b32 v55, v225, v7
    s_waitcnt vmcnt(18)
    s_nop 0
    v_mfma_f32_16x16x32_bf16 v[56:59], v[52:55], v[148:151], v[56:59]
    v_perm_b32 v225, v43, v43, s36
    v_and_b32 v8, v225, v4
    v_and_b32 v9, v225, v5
    v_and_b32 v10, v225, v6
    v_and_b32 v11, v225, v7
    s_waitcnt vmcnt(17)
    s_nop 0
    v_mfma_f32_16x16x32_bf16 v[56:59], v[8:11], v[152:155], v[56:59]
    v_perm_b32 v225, v43, v43, s37
    v_and_b32 v52, v225, v4
    v_and_b32 v53, v225, v5
    v_and_b32 v54, v225, v6
    v_and_b32 v55, v225, v7
    s_waitcnt vmcnt(16)
    s_nop 0
    v_mfma_f32_16x16x32_bf16 v[56:59], v[52:55], v[156:159], v[56:59]
    v_perm_b32 v225, v44, v44, s36
    v_and_b32 v8, v225, v4
    v_and_b32 v9, v225, v5
    v_and_b32 v10, v225, v6
    v_and_b32 v11, v225, v7
    s_waitcnt vmcnt(15)
    s_nop 0
    v_mfma_f32_16x16x32_bf16 v[56:59], v[8:11], v[160:163], v[56:59]
    v_perm_b32 v225, v44, v44, s37
    v_and_b32 v52, v225, v4
    v_and_b32 v53, v225, v5
    v_and_b32 v54, v225, v6
    v_and_b32 v55, v225, v7
    s_waitcnt vmcnt(14)
    s_nop 0
    v_mfma_f32_16x16x32_bf16 v[56:59], v[52:55], v[164:167], v[56:59]
    v_perm_b32 v225, v45, v45, s36
    v_and_b32 v8, v225, v4
    v_and_b32 v9, v225, v5
    v_and_b32 v10, v225, v6
    v_and_b32 v11, v225, v7
    s_waitcnt vmcnt(13)
    s_nop 0
    v_mfma_f32_16x16x32_bf16 v[56:59], v[8:11], v[168:171], v[56:59]
    v_perm_b32 v225, v45, v45, s37
    v_and_b32 v52, v225, v4
    v_and_b32 v53, v225, v5
    v_and_b32 v54, v225, v6
    v_and_b32 v55, v225, v7
    s_waitcnt vmcnt(12)
    s_nop 0
    v_mfma_f32_16x16x32_bf16 v[56:59], v[52:55], v[172:175], v[56:59]
    v_perm_b32 v225, v46, v46, s36
    v_and_b32 v8, v225, v4
    v_and_b32 v9, v225, v5
    v_and_b32 v10, v225, v6
    v_and_b32 v11, v225, v7
    s_waitcnt vmcnt(11)
    s_nop 0
    v_mfma_f32_16x16x32_bf16 v[56:59], v[8:11], v[176:179], v[56:59]
    v_perm_b32 v225, v46, v46, s37
    v_and_b32 v52, v225, v4
    v_and_b32 v53, v225, v5
    v_and_b32 v54, v225, v6
    v_and_b32 v55, v225, v7
    s_waitcnt vmcnt(10)
    s_nop 0
    v_mfma_f32_16x16x32_bf16 v[56:59], v[52:55], v[180:183], v[56:59]
    v_perm_b32 v225, v47, v47, s36
    v_and_b32 v8, v225, v4
    v_and_b32 v9, v225, v5
    v_and_b32 v10, v225, v6
    v_and_b32 v11, v225, v7
    s_waitcnt vmcnt(9)
    s_nop 0
    v_mfma_f32_16x16x32_bf16 v[56:59], v[8:11], v[184:187], v[56:59]
    v_perm_b32 v225, v47, v47, s37
    v_and_b32 v52, v225, v4
    v_and_b32 v53, v225, v5
    v_and_b32 v54, v225, v6
    v_and_b32 v55, v225, v7
    s_waitcnt vmcnt(8)
    s_nop 0
    v_mfma_f32_16x16x32_bf16 v[56:59], v[52:55], v[188:191], v[56:59]
    v_perm_b32 v225, v48, v48, s36
    v_and_b32 v8, v225, v4
    v_and_b32 v9, v225, v5
    v_and_b32 v10, v225, v6
    v_and_b32 v11, v225, v7
    s_waitcnt vmcnt(7)
    s_nop 0
    v_mfma_f32_16x16x32_bf16 v[56:59], v[8:11], v[192:195], v[56:59]
    v_perm_b32 v225, v48, v48, s37
    v_and_b32 v52, v225, v4
    v_and_b32 v53, v225, v5
    v_and_b32 v54, v225, v6
    v_and_b32 v55, v225, v7
    s_waitcnt vmcnt(6)
    s_nop 0
    v_mfma_f32_16x16x32_bf16 v[56:59], v[52:55], v[196:199], v[56:59]
    v_perm_b32 v225, v49, v49, s36
    v_and_b32 v8, v225, v4
    v_and_b32 v9, v225, v5
    v_and_b32 v10, v225, v6
    v_and_b32 v11, v225, v7
    s_waitcnt vmcnt(5)
    s_nop 0
    v_mfma_f32_16x16x32_bf16 v[56:59], v[8:11], v[200:203], v[56:59]
    v_perm_b32 v225, v49, v49, s37
    v_and_b32 v52, v225, v4
    v_and_b32 v53, v225, v5
    v_and_b32 v54, v225, v6
    v_and_b32 v55, v225, v7
    s_waitcnt vmcnt(4)
    s_nop 0
    v_mfma_f32_16x16x32_bf16 v[56:59], v[52:55], v[204:207], v[56:59]
    v_perm_b32 v225, v50, v50, s36
    v_and_b32 v8, v225, v4
    v_and_b32 v9, v225, v5
    v_and_b32 v10, v225, v6
    v_and_b32 v11, v225, v7
    s_waitcnt vmcnt(3)
    s_nop 0
    v_mfma_f32_16x16x32_bf16 v[56:59], v[8:11], v[208:211], v[56:59]
    v_perm_b32 v225, v50, v50, s37
    v_and_b32 v52, v225, v4
    v_and_b32 v53, v225, v5
    v_and_b32 v54, v225, v6
    v_and_b32 v55, v225, v7
    s_waitcnt vmcnt(2)
    s_nop 0
    v_mfma_f32_16x16x32_bf16 v[56:59], v[52:55], v[212:215], v[56:59]
    v_perm_b32 v225, v51, v51, s36
    v_and_b32 v8, v225, v4
    v_and_b32 v9, v225, v5
    v_and_b32 v10, v225, v6
    v_and_b32 v11, v225, v7
    s_waitcnt vmcnt(1)
    s_nop 0
    v_mfma_f32_16x16x32_bf16 v[56:59], v[8:11], v[216:219], v[56:59]
    v_perm_b32 v225, v51, v51, s37
    v_and_b32 v52, v225, v4
    v_and_b32 v53, v225, v5
    v_and_b32 v54, v225, v6
    v_and_b32 v55, v225, v7
    s_waitcnt vmcnt(0)
    s_nop 0
    v_mfma_f32_16x16x32_bf16 v[56:59], v[52:55], v[220:223], v[56:59]
    v_lshlrev_b32 v3, 4, v1
    v_lshl_add_u32 v3, v2, 5, v3
    s_lshl_b32 s21, s20, 9
    v_add3_u32 v226, v3, s21, v228
    s_mov_b32 exec_hi, 0
    s_nop 2
    ds_write_b128 v226, v[56:59] offset:256
    s_mov_b64 exec, -1
    v_mov_b32 v225, 1
    s_waitcnt lgkmcnt(0)
    s_mov_b64 exec, 1
    ds_add_rtn_u32 v225, v228, v225 offset:32
    s_mov_b64 exec, -1
    s_waitcnt lgkmcnt(0)
    v_readfirstlane_b32 s21, v225
    s_nop 0
    s_cmp_lg_u32 s21, 3
    s_cbranch_scc1 L_s_qdone
    v_lshl_add_u32 v226, v0, 3, v228
    ds_read_b64 v[64:65], v226 offset:256
    ds_read_b64 v[66:67], v226 offset:768
    ds_read_b64 v[68:69], v226 offset:1280
    ds_read_b64 v[70:71], v226 offset:1792
    s_waitcnt lgkmcnt(0)
    v_add_f32 v64, v64, v66
    v_add_f32 v65, v65, v67
    v_add_f32 v68, v68, v70
    v_add_f32 v69, v69, v71
    v_add_f32 v64, v64, v68
    v_add_f32 v65, v65, v69
    v_cvt_pk_bf16_f32 v64, v64, v65
    v_lshl_add_u32 v226, v0, 2, v228
    ds_write_b32 v226, v64 offset:2304
    v_mov_b32 v225, 1
    s_waitcnt lgkmcnt(0)
    ds_write_b32 v228, v225 offset:36
L_s_qdone:
    s_cmp_lg_u32 s20, 0
    s_cbranch_scc1 L_s_nosent
    s_load_dwordx2 s[64:65], s[0:1], 96
    s_load_dwordx2 s[68:69], s[0:1], 88
    v_lshlrev_b32 v3, 4, v0
    v_mov_b32 v64, -1
    v_mov_b32 v65, -1
    v_mov_b32 v66, -1
    v_mov_b32 v67, -1
    s_mul_i32 s21, s18, 2048
    s_mov_b32 s66, 1280
    s_mov_b32 s67, 0x20000
    s_waitcnt lgkmcnt(0)
    s_add_u32 s64, s64, s21
    s_addc_u32 s65, s65, 0
    buffer_store_dwordx4 v[64:67], v3, s[64:67], 0 offen offset:0 sc1
    buffer_store_dwordx4 v[64:67], v3, s[64:67], 0 offen offset:1024 sc1
    s_waitcnt vmcnt(0)
L_s_nosent:
    s_mov_b32 s8, s34
    s_mov_b32 s9, s35
    s_mov_b32 s10, 1280
    s_mov_b32 s11, 0x20000
    v_lshlrev_b32 v3, 4, v0
    buffer_load_dwordx4 v[64:67], v3, s[4:7], 0 offen
    buffer_load_dwordx4 v[68:71], v3, s[4:7], 0 offen offset:1024
    buffer_load_dwordx4 v[72:75], v3, s[8:11], 0 offen
    buffer_load_dwordx4 v[76:79], v3, s[8:11], 0 offen offset:1024
    v_mov_b32 v229, 0
    s_waitcnt vmcnt(0)
    v_lshlrev_b32 v224, 16, v64
    v_lshlrev_b32 v225, 16, v72
    v_and_b32 v226, 0xffff0000, v64
    v_and_b32 v227, 0xffff0000, v72
    v_mul_f32 v224, v224, v225
    v_mul_f32 v226, v226, v227
    v_cvt_pk_bf16_f32 v224, v224, v226
    v_lshlrev_b32 v225, 16, v224
    v_and_b32 v226, 0xffff0000, v224
    v_add_f32 v229, v229, v225
    v_add_f32 v229, v229, v226
    v_lshlrev_b32 v224, 16, v65
    v_lshlrev_b32 v225, 16, v73
    v_and_b32 v226, 0xffff0000, v65
    v_and_b32 v227, 0xffff0000, v73
    v_mul_f32 v224, v224, v225
    v_mul_f32 v226, v226, v227
    v_cvt_pk_bf16_f32 v224, v224, v226
    v_lshlrev_b32 v225, 16, v224
    v_and_b32 v226, 0xffff0000, v224
    v_add_f32 v229, v229, v225
    v_add_f32 v229, v229, v226
    v_lshlrev_b32 v224, 16, v66
    v_lshlrev_b32 v225, 16, v74
    v_and_b32 v226, 0xffff0000, v66
    v_and_b32 v227, 0xffff0000, v74
    v_mul_f32 v224, v224, v225
    v_mul_f32 v226, v226, v227
    v_cvt_pk_bf16_f32 v224, v224, v226
    v_lshlrev_b32 v225, 16, v224
    v_and_b32 v226, 0xffff0000, v224
    v_add_f32 v229, v229, v225
    v_add_f32 v229, v229, v226
    v_lshlrev_b32 v224, 16, v67
    v_lshlrev_b32 v225, 16, v75
    v_and_b32 v226, 0xffff0000, v67
    v_and_b32 v227, 0xffff0000, v75
    v_mul_f32 v224, v224, v225
    v_mul_f32 v226, v226, v227
    v_cvt_pk_bf16_f32 v224, v224, v226
    v_lshlrev_b32 v225, 16, v224
    v_and_b32 v226, 0xffff0000, v224
    v_add_f32 v229, v229, v225
    v_add_f32 v229, v229, v226
    v_lshlrev_b32 v224, 16, v68
    v_lshlrev_b32 v225, 16, v76
    v_and_b32 v226, 0xffff0000, v68
    v_and_b32 v227, 0xffff0000, v76
    v_mul_f32 v224, v224, v225
    v_mul_f32 v226, v226, v227
    v_cvt_pk_bf16_f32 v224, v224, v226
    v_lshlrev_b32 v225, 16, v224
    v_and_b32 v226, 0xffff0000, v224
    v_add_f32 v229, v229, v225
    v_add_f32 v229, v229, v226
    v_lshlrev_b32 v224, 16, v69
    v_lshlrev_b32 v225, 16, v77
    v_and_b32 v226, 0xffff0000, v69
    v_and_b32 v227, 0xffff0000, v77
    v_mul_f32 v224, v224, v225
    v_mul_f32 v226, v226, v227
    v_cvt_pk_bf16_f32 v224, v224, v226
    v_lshlrev_b32 v225, 16, v224
    v_and_b32 v226, 0xffff0000, v224
    v_add_f32 v229, v229, v225
    v_add_f32 v229, v229, v226
    v_lshlrev_b32 v224, 16, v70
    v_lshlrev_b32 v225, 16, v78
    v_and_b32 v226, 0xffff0000, v70
    v_and_b32 v227, 0xffff0000, v78
    v_mul_f32 v224, v224, v225
    v_mul_f32 v226, v226, v227
    v_cvt_pk_bf16_f32 v224, v224, v226
    v_lshlrev_b32 v225, 16, v224
    v_and_b32 v226, 0xffff0000, v224
    v_add_f32 v229, v229, v225
    v_add_f32 v229, v229, v226
    v_lshlrev_b32 v224, 16, v71
    v_lshlrev_b32 v225, 16, v79
    v_and_b32 v226, 0xffff0000, v71
    v_and_b32 v227, 0xffff0000, v79
    v_mul_f32 v224, v224, v225
    v_mul_f32 v226, v226, v227
    v_cvt_pk_bf16_f32 v224, v224, v226
    v_lshlrev_b32 v225, 16, v224
    v_and_b32 v226, 0xffff0000, v224
    v_add_f32 v229, v229, v225
    v_add_f32 v229, v229, v226
    s_nop 1
    v_add_f32_dpp v229, v229, v229 row_ror:1 row_mask:0xf bank_mask:0xf
    s_nop 1
    v_add_f32_dpp v229, v229, v229 row_ror:2 row_mask:0xf bank_mask:0xf
    s_nop 1
    v_add_f32_dpp v229, v229, v229 row_ror:4 row_mask:0xf bank_mask:0xf
    s_nop 1
    v_add_f32_dpp v229, v229, v229 row_ror:8 row_mask:0xf bank_mask:0xf
    s_nop 1
    v_add_f32_dpp v229, v229, v229 row_bcast:15 row_mask:0xa bank_mask:0xf
    s_nop 1
    v_add_f32_dpp v229, v229, v229 row_bcast:31 row_mask:0xc bank_mask:0xf
    s_nop 0
    v_readlane_b32 s21, v229, 63
    s_nop 1
    v_mov_b32 v229, s21
    v_cvt_pk_bf16_f32 v229, v229, v229
    v_and_b32 v229, 0xffff0000, v229
    v_mul_f32 v229, 0xbfb8aa3b, v229
    v_exp_f32 v229, v229
    s_nop 0
    v_add_f32 v229, 1.0, v229
    v_rcp_f32 v229, v229
    s_nop 0
    v_cvt_pk_bf16_f32 v229, v229, v229
    v_and_b32 v229, 0xffff0000, v229
    v_sub_f32 v230, 1.0, v229
    v_cvt_pk_bf16_f32 v230, v230, v230
    v_and_b32 v230, 0xffff0000, v230
    v_mov_b32 v12, 0
    v_mov_b32 v13, 0
    v_mov_b32 v14, 0
    v_mov_b32 v15, 0
    v_mov_b32 v16, 0
    v_mov_b32 v17, 0
    v_mov_b32 v18, 0
    v_mov_b32 v19, 0
    v_mov_b32 v20, 0
    v_mov_b32 v21, 0
    v_mov_b32 v22, 0
    v_mov_b32 v23, 0
    v_mov_b32 v24, 0
    v_mov_b32 v25, 0
    v_mov_b32 v26, 0
    v_mov_b32 v27, 0
    v_mov_b32 v28, 0
    v_mov_b32 v29, 0
    v_mov_b32 v30, 0
    v_mov_b32 v31, 0
    s_mov_b32 s62, s16
    s_cmp_gt_u32 s16, 9
    s_cselect_b32 s21, 1, 0
    s_sub_u32 s62, s62, s21
    s_cmp_gt_u32 s16, 13
    s_cselect_b32 s21, 1, 0
    s_sub_u32 s62, s62, s21
    s_cmp_gt_u32 s16, 17
    s_cselect_b32 s21, 1, 0
    s_sub_u32 s62, s62, s21
    s_cmp_gt_u32 s16, 21
    s_cselect_b32 s21, 1, 0
    s_sub_u32 s62, s62, s21
    s_cmp_gt_u32 s16, 25
    s_cselect_b32 s21, 1, 0
    s_sub_u32 s62, s62, s21
    s_cmp_eq_u32 s16, 9
    s_cselect_b32 s62, 27, s62
    s_cmp_eq_u32 s16, 13
    s_cselect_b32 s62, 27, s62
    s_cmp_eq_u32 s16, 17
    s_cselect_b32 s62, 27, s62
    s_cmp_eq_u32 s16, 21
    s_cselect_b32 s62, 27, s62
    s_cmp_eq_u32 s16, 25
    s_cselect_b32 s62, 27, s62
    s_cmp_ge_u32 s62, 27
    s_cbranch_scc1 L_s_noffn
    v_lshrrev_b32 v3, 4, v0
    v_lshlrev_b32 v3, 3, v3
    s_add_u32 s50, s20, 0
    s_lshl_b32 s21, s50, 5
    buffer_load_dwordx2 v[32:33], v3, s[4:7], s21 offen
    s_add_u32 s51, s20, 4
    s_lshl_b32 s21, s51, 5
    buffer_load_dwordx2 v[34:35], v3, s[4:7], s21 offen
    s_add_u32 s52, s20, 8
    s_lshl_b32 s21, s52, 5
    buffer_load_dwordx2 v[36:37], v3, s[4:7], s21 offen
    s_add_u32 s53, s20, 12
    s_lshl_b32 s21, s53, 5
    buffer_load_dwordx2 v[38:39], v3, s[4:7], s21 offen
    s_add_u32 s54, s20, 16
    s_lshl_b32 s21, s54, 5
    buffer_load_dwordx2 v[40:41], v3, s[4:7], s21 offen
    s_add_u32 s55, s20, 20
    s_lshl_b32 s21, s55, 5
    buffer_load_dwordx2 v[42:43], v3, s[4:7], s21 offen
    s_add_u32 s56, s20, 24
    s_lshl_b32 s21, s56, 5
    buffer_load_dwordx2 v[44:45], v3, s[4:7], s21 offen
    s_add_u32 s57, s20, 28
    s_lshl_b32 s21, s57, 5
    buffer_load_dwordx2 v[46:47], v3, s[4:7], s21 offen
    s_add_u32 s58, s20, 32
    s_lshl_b32 s21, s58, 5
    buffer_load_dwordx2 v[48:49], v3, s[4:7], s21 offen
    s_add_u32 s59, s20, 36
    s_lshl_b32 s21, s59, 5
    buffer_load_dwordx2 v[50:51], v3, s[4:7], s21 offen
    s_waitcnt vmcnt(0)
    v_cmp_gt_u32 vcc, 8, v2
    v_mov_b32 v224, s30
    v_mov_b32 v225, s28
    v_cndmask_b32 v60, v224, v225, vcc
    v_mov_b32 v224, s31
    v_mov_b32 v225, s29
    v_cndmask_b32 v61, v224, v225, vcc
    s_movk_i32 s21, 13824
    v_mul_lo_u32 v224, v1, s21
    v_and_b32 v225, 7, v2
    v_lshl_add_u32 v224, v225, 4, v224
    s_lshl_b32 s21, s62, 7
    v_add_u32 v224, s21, v224
    v_mov_b32 v225, 0
    v_lshl_add_u64 v[250:251], v[224:225], 0, v[60:61]
    s_mov_b32 s38, 6912
    s_mov_b32 s39, 0
    s_mov_b32 s41, 0
    s_mul_i32 s40, s50, 55296
    v_lshl_add_u64 v[60:61], v[250:251], 0, s[40:41]
    global_load_dwordx4 v[64:67], v[60:61], off offset:0 nt
    global_load_dwordx4 v[68:71], v[60:61], off offset:3456 nt
    v_lshl_add_u64 v[60:61], v[60:61], 0, s[38:39]
    v_perm_b32 v225, v32, v32, s36
    v_and_b32 v8, v225, v4
    v_and_b32 v9, v225, v5
    v_and_b32 v10, v225, v6
    v_and_b32 v11, v225, v7
    s_waitcnt vmcnt(1)
    global_load_dwordx4 v[72:75], v[60:61], off offset:0 nt
    v_mfma_f32_16x16x32_bf16 v[56:59], v[8:11], v[64:67], 0
    v_perm_b32 v225, v32, v32, s37
    v_and_b32 v52, v225, v4
    v_and_b32 v53, v225, v5
    v_and_b32 v54, v225, v6
    v_and_b32 v55, v225, v7
    s_waitcnt vmcnt(1)
    global_load_dwordx4 v[76:79], v[60:61], off offset:3456 nt
    v_mfma_f32_16x16x32_bf16 v[56:59], v[52:55], v[68:71], v[56:59]
    v_perm_b32 v225, v33, v33, s36
    v_and_b32 v8, v225, v4
    v_and_b32 v9, v225, v5
    v_and_b32 v10, v225, v6
    v_and_b32 v11, v225, v7
    s_waitcnt vmcnt(1)
    s_mul_i32 s40, s51, 55296
    v_lshl_add_u64 v[60:61], v[250:251], 0, s[40:41]
    global_load_dwordx4 v[80:83], v[60:61], off offset:0 nt
    v_mfma_f32_16x16x32_bf16 v[56:59], v[8:11], v[72:75], v[56:59]
    v_perm_b32 v225, v33, v33, s37
    v_and_b32 v52, v225, v4
    v_and_b32 v53, v225, v5
    v_and_b32 v54, v225, v6
    v_and_b32 v55, v225, v7
    s_waitcnt vmcnt(1)
    global_load_dwordx4 v[84:87], v[60:61], off offset:3456 nt
    v_lshl_add_u64 v[60:61], v[60:61], 0, s[38:39]
    v_mfma_f32_16x16x32_bf16 v[56:59], v[52:55], v[76:79], v[56:59]
    v_perm_b32 v225, v34, v34, s36
    v_and_b32 v8, v225, v4
    v_and_b32 v9, v225, v5
    v_and_b32 v10, v225, v6
    v_and_b32 v11, v225, v7
    s_waitcnt vmcnt(1)
    global_load_dwordx4 v[88:91], v[60:61], off offset:0 nt
    v_mfma_f32_16x16x32_bf16 v[56:59], v[8:11], v[80:83], v[56:59]
    v_perm_b32 v225, v34, v34, s37
    v_and_b32 v52, v225, v4
    v_and_b32 v53, v225, v5
    v_and_b32 v54, v225, v6
    v_and_b32 v55, v225, v7
    s_waitcnt vmcnt(1)
    global_load_dwordx4 v[92:95], v[60:61], off offset:3456 nt
    v_mfma_f32_16x16x32_bf16 v[56:59], v[52:55], v[84:87], v[56:59]
    v_perm_b32 v225, v35, v35, s36
    v_and_b32 v8, v225, v4
    v_and_b32 v9, v225, v5
    v_and_b32 v10, v225, v6
    v_and_b32 v11, v225, v7
    s_waitcnt vmcnt(1)
    s_mul_i32 s40, s52, 55296
    v_lshl_add_u64 v[60:61], v[250:251], 0, s[40:41]
    global_load_dwordx4 v[96:99], v[60:61], off offset:0 nt
    v_mfma_f32_16x16x32_bf16 v[56:59], v[8:11], v[88:91], v[56:59]
    v_perm_b32 v225, v35, v35, s37
    v_and_b32 v52, v225, v4
    v_and_b32 v53, v225, v5
    v_and_b32 v54, v225, v6
    v_and_b32 v55, v225, v7
    s_waitcnt vmcnt(1)
    global_load_dwordx4 v[100:103], v[60:61], off offset:3456 nt
    v_lshl_add_u64 v[60:61], v[60:61], 0, s[38:39]
    v_mfma_f32_16x16x32_bf16 v[56:59], v[52:55], v[92:95], v[56:59]
    v_perm_b32 v225, v36, v36, s36
    v_and_b32 v8, v225, v4
    v_and_b32 v9, v225, v5
    v_and_b32 v10, v225, v6
    v_and_b32 v11, v225, v7
    s_waitcnt vmcnt(1)
    global_load_dwordx4 v[104:107], v[60:61], off offset:0 nt
    v_mfma_f32_16x16x32_bf16 v[56:59], v[8:11], v[96:99], v[56:59]
    v_perm_b32 v225, v36, v36, s37
    v_and_b32 v52, v225, v4
    v_and_b32 v53, v225, v5
    v_and_b32 v54, v225, v6
    v_and_b32 v55, v225, v7
    s_waitcnt vmcnt(1)
    global_load_dwordx4 v[108:111], v[60:61], off offset:3456 nt
    v_mfma_f32_16x16x32_bf16 v[56:59], v[52:55], v[100:103], v[56:59]
    v_perm_b32 v225, v37, v37, s36
    v_and_b32 v8, v225, v4
    v_and_b32 v9, v225, v5
    v_and_b32 v10, v225, v6
    v_and_b32 v11, v225, v7
    s_waitcnt vmcnt(1)
    s_mul_i32 s40, s53, 55296
    v_lshl_add_u64 v[60:61], v[250:251], 0, s[40:41]
    global_load_dwordx4 v[112:115], v[60:61], off offset:0 nt
    v_mfma_f32_16x16x32_bf16 v[56:59], v[8:11], v[104:107], v[56:59]
    v_perm_b32 v225, v37, v37, s37
    v_and_b32 v52, v225, v4
    v_and_b32 v53, v225, v5
    v_and_b32 v54, v225, v6
    v_and_b32 v55, v225, v7
    s_waitcnt vmcnt(1)
    global_load_dwordx4 v[116:119], v[60:61], off offset:3456 nt
    v_lshl_add_u64 v[60:61], v[60:61], 0, s[38:39]
    v_mfma_f32_16x16x32_bf16 v[56:59], v[52:55], v[108:111], v[56:59]
    v_perm_b32 v225, v38, v38, s36
    v_and_b32 v8, v225, v4
    v_and_b32 v9, v225, v5
    v_and_b32 v10, v225, v6
    v_and_b32 v11, v225, v7
    s_waitcnt vmcnt(1)
    global_load_dwordx4 v[120:123], v[60:61], off offset:0 nt
    v_mfma_f32_16x16x32_bf16 v[56:59], v[8:11], v[112:115], v[56:59]
    v_perm_b32 v225, v38, v38, s37
    v_and_b32 v52, v225, v4
    v_and_b32 v53, v225, v5
    v_and_b32 v54, v225, v6
    v_and_b32 v55, v225, v7
    s_waitcnt vmcnt(1)
    global_load_dwordx4 v[124:127], v[60:61], off offset:3456 nt
    v_mfma_f32_16x16x32_bf16 v[56:59], v[52:55], v[116:119], v[56:59]
    v_perm_b32 v225, v39, v39, s36
    v_and_b32 v8, v225, v4
    v_and_b32 v9, v225, v5
    v_and_b32 v10, v225, v6
    v_and_b32 v11, v225, v7
    s_waitcnt vmcnt(1)
    s_mul_i32 s40, s54, 55296
    v_lshl_add_u64 v[60:61], v[250:251], 0, s[40:41]
    global_load_dwordx4 v[128:131], v[60:61], off offset:0 nt
    v_mfma_f32_16x16x32_bf16 v[56:59], v[8:11], v[120:123], v[56:59]
    v_perm_b32 v225, v39, v39, s37
    v_and_b32 v52, v225, v4
    v_and_b32 v53, v225, v5
    v_and_b32 v54, v225, v6
    v_and_b32 v55, v225, v7
    s_waitcnt vmcnt(1)
    global_load_dwordx4 v[132:135], v[60:61], off offset:3456 nt
    v_lshl_add_u64 v[60:61], v[60:61], 0, s[38:39]
    v_mfma_f32_16x16x32_bf16 v[56:59], v[52:55], v[124:127], v[56:59]
    v_perm_b32 v225, v40, v40, s36
    v_and_b32 v8, v225, v4
    v_and_b32 v9, v225, v5
    v_and_b32 v10, v225, v6
    v_and_b32 v11, v225, v7
    s_waitcnt vmcnt(1)
    global_load_dwordx4 v[136:139], v[60:61], off offset:0 nt
    v_mfma_f32_16x16x32_bf16 v[56:59], v[8:11], v[128:131], v[56:59]
    v_perm_b32 v225, v40, v40, s37
    v_and_b32 v52, v225, v4
    v_and_b32 v53, v225, v5
    v_and_b32 v54, v225, v6
    v_and_b32 v55, v225, v7
    s_waitcnt vmcnt(1)
    global_load_dwordx4 v[140:143], v[60:61], off offset:3456 nt
    v_mfma_f32_16x16x32_bf16 v[56:59], v[52:55], v[132:135], v[56:59]
    v_perm_b32 v225, v41, v41, s36
    v_and_b32 v8, v225, v4
    v_and_b32 v9, v225, v5
    v_and_b32 v10, v225, v6
    v_and_b32 v11, v225, v7
    s_waitcnt vmcnt(1)
    s_mul_i32 s40, s55, 55296
    v_lshl_add_u64 v[60:61], v[250:251], 0, s[40:41]
    global_load_dwordx4 v[144:147], v[60:61], off offset:0 nt
    v_mfma_f32_16x16x32_bf16 v[56:59], v[8:11], v[136:139], v[56:59]
    v_perm_b32 v225, v41, v41, s37
    v_and_b32 v52, v225, v4
    v_and_b32 v53, v225, v5
    v_and_b32 v54, v225, v6
    v_and_b32 v55, v225, v7
    s_waitcnt vmcnt(1)
    global_load_dwordx4 v[148:151], v[60:61], off offset:3456 nt
    v_lshl_add_u64 v[60:61], v[60:61], 0, s[38:39]
    v_mfma_f32_16x16x32_bf16 v[56:59], v[52:55], v[140:143], v[56:59]
    v_perm_b32 v225, v42, v42, s36
    v_and_b32 v8, v225, v4
    v_and_b32 v9, v225, v5
    v_and_b32 v10, v225, v6
    v_and_b32 v11, v225, v7
    s_waitcnt vmcnt(1)
    global_load_dwordx4 v[152:155], v[60:61], off offset:0 nt
    v_mfma_f32_16x16x32_bf16 v[56:59], v[8:11], v[144:147], v[56:59]
    v_perm_b32 v225, v42, v42, s37
    v_and_b32 v52, v225, v4
    v_and_b32 v53, v225, v5
    v_and_b32 v54, v225, v6
    v_and_b32 v55, v225, v7
    s_waitcnt vmcnt(1)
    global_load_dwordx4 v[156:159], v[60:61], off offset:3456 nt
    v_mfma_f32_16x16x32_bf16 v[56:59], v[52:55], v[148:151], v[56:59]
    v_perm_b32 v225, v43, v43, s36
    v_and_b32 v8, v225, v4
    v_and_b32 v9, v225, v5
    v_and_b32 v10, v225, v6
    v_and_b32 v11, v225, v7
    s_waitcnt vmcnt(1)
    s_mul_i32 s40, s56, 55296
    v_lshl_add_u64 v[60:61], v[250:251], 0, s[40:41]
    global_load_dwordx4 v[160:163], v[60:61], off offset:0 nt
    v_mfma_f32_16x16x32_bf16 v[56:59], v[8:11], v[152:155], v[56:59]
    v_perm_b32 v225, v43, v43, s37
    v_and_b32 v52, v225, v4
    v_and_b32 v53, v225, v5
    v_and_b32 v54, v225, v6
    v_and_b32 v55, v225, v7
    s_waitcnt vmcnt(1)
    global_load_dwordx4 v[164:167], v[60:61], off offset:3456 nt
    v_lshl_add_u64 v[60:61], v[60:61], 0, s[38:39]
    v_mfma_f32_16x16x32_bf16 v[56:59], v[52:55], v[156:159], v[56:59]
    v_perm_b32 v225, v44, v44, s36
    v_and_b32 v8, v225, v4
    v_and_b32 v9, v225, v5
    v_and_b32 v10, v225, v6
    v_and_b32 v11, v225, v7
    s_waitcnt vmcnt(1)
    global_load_dwordx4 v[168:171], v[60:61], off offset:0 nt
    v_mfma_f32_16x16x32_bf16 v[56:59], v[8:11], v[160:163], v[56:59]
    v_perm_b32 v225, v44, v44, s37
    v_and_b32 v52, v225, v4
    v_and_b32 v53, v225, v5
    v_and_b32 v54, v225, v6
    v_and_b32 v55, v225, v7
    s_waitcnt vmcnt(1)
    global_load_dwordx4 v[172:175], v[60:61], off offset:3456 nt
    v_mfma_f32_16x16x32_bf16 v[56:59], v[52:55], v[164:167], v[56:59]
    v_perm_b32 v225, v45, v45, s36
    v_and_b32 v8, v225, v4
    v_and_b32 v9, v225, v5
    v_and_b32 v10, v225, v6
    v_and_b32 v11, v225, v7
    s_waitcnt vmcnt(1)
    s_mul_i32 s40, s57, 55296
    v_lshl_add_u64 v[60:61], v[250:251], 0, s[40:41]
    global_load_dwordx4 v[176:179], v[60:61], off offset:0 nt
    v_mfma_f32_16x16x32_bf16 v[56:59], v[8:11], v[168:171], v[56:59]
    v_perm_b32 v225, v45, v45, s37
    v_and_b32 v52, v225, v4
    v_and_b32 v53, v225, v5
    v_and_b32 v54, v225, v6
    v_and_b32 v55, v225, v7
    s_waitcnt vmcnt(1)
    global_load_dwordx4 v[180:183], v[60:61], off offset:3456 nt
    v_lshl_add_u64 v[60:61], v[60:61], 0, s[38:39]
    v_mfma_f32_16x16x32_bf16 v[56:59], v[52:55], v[172:175], v[56:59]
    v_perm_b32 v225, v46, v46, s36
    v_and_b32 v8, v225, v4
    v_and_b32 v9, v225, v5
    v_and_b32 v10, v225, v6
    v_and_b32 v11, v225, v7
    s_waitcnt vmcnt(1)
    global_load_dwordx4 v[184:187], v[60:61], off offset:0 nt
    v_mfma_f32_16x16x32_bf16 v[56:59], v[8:11], v[176:179], v[56:59]
    v_perm_b32 v225, v46, v46, s37
    v_and_b32 v52, v225, v4
    v_and_b32 v53, v225, v5
    v_and_b32 v54, v225, v6
    v_and_b32 v55, v225, v7
    s_waitcnt vmcnt(1)
    global_load_dwordx4 v[188:191], v[60:61], off offset:3456 nt
    v_mfma_f32_16x16x32_bf16 v[56:59], v[52:55], v[180:183], v[56:59]
    v_perm_b32 v225, v47, v47, s36
    v_and_b32 v8, v225, v4
    v_and_b32 v9, v225, v5
    v_and_b32 v10, v225, v6
    v_and_b32 v11, v225, v7
    s_waitcnt vmcnt(1)
    s_mul_i32 s40, s58, 55296
    v_lshl_add_u64 v[60:61], v[250:251], 0, s[40:41]
    global_load_dwordx4 v[192:195], v[60:61], off offset:0 nt
    v_mfma_f32_16x16x32_bf16 v[56:59], v[8:11], v[184:187], v[56:59]
    v_perm_b32 v225, v47, v47, s37
    v_and_b32 v52, v225, v4
    v_and_b32 v53, v225, v5
    v_and_b32 v54, v225, v6
    v_and_b32 v55, v225, v7
    s_waitcnt vmcnt(1)
    global_load_dwordx4 v[196:199], v[60:61], off offset:3456 nt
    v_lshl_add_u64 v[60:61], v[60:61], 0, s[38:39]
    v_mfma_f32_16x16x32_bf16 v[56:59], v[52:55], v[188:191], v[56:59]
    v_perm_b32 v225, v48, v48, s36
    v_and_b32 v8, v225, v4
    v_and_b32 v9, v225, v5
    v_and_b32 v10, v225, v6
    v_and_b32 v11, v225, v7
    s_waitcnt vmcnt(1)
    global_load_dwordx4 v[200:203], v[60:61], off offset:0 nt
    v_mfma_f32_16x16x32_bf16 v[56:59], v[8:11], v[192:195], v[56:59]
    v_perm_b32 v225, v48, v48, s37
    v_and_b32 v52, v225, v4
    v_and_b32 v53, v225, v5
    v_and_b32 v54, v225, v6
    v_and_b32 v55, v225, v7
    s_waitcnt vmcnt(1)
    global_load_dwordx4 v[204:207], v[60:61], off offset:3456 nt
    v_mfma_f32_16x16x32_bf16 v[56:59], v[52:55], v[196:199], v[56:59]
    v_perm_b32 v225, v49, v49, s36
    v_and_b32 v8, v225, v4
    v_and_b32 v9, v225, v5
    v_and_b32 v10, v225, v6
    v_and_b32 v11, v225, v7
    s_waitcnt vmcnt(1)
    s_mul_i32 s40, s59, 55296
    v_lshl_add_u64 v[60:61], v[250:251], 0, s[40:41]
    global_load_dwordx4 v[208:211], v[60:61], off offset:0 nt
    v_mfma_f32_16x16x32_bf16 v[56:59], v[8:11], v[200:203], v[56:59]
    v_perm_b32 v225, v49, v49, s37
    v_and_b32 v52, v225, v4
    v_and_b32 v53, v225, v5
    v_and_b32 v54, v225, v6
    v_and_b32 v55, v225, v7
    s_waitcnt vmcnt(1)
    global_load_dwordx4 v[212:215], v[60:61], off offset:3456 nt
    v_lshl_add_u64 v[60:61], v[60:61], 0, s[38:39]
    v_mfma_f32_16x16x32_bf16 v[56:59], v[52:55], v[204:207], v[56:59]
    v_perm_b32 v225, v50, v50, s36
    v_and_b32 v8, v225, v4
    v_and_b32 v9, v225, v5
    v_and_b32 v10, v225, v6
    v_and_b32 v11, v225, v7
    s_waitcnt vmcnt(1)
    global_load_dwordx4 v[216:219], v[60:61], off offset:0 nt
    v_mfma_f32_16x16x32_bf16 v[56:59], v[8:11], v[208:211], v[56:59]
    v_perm_b32 v225, v50, v50, s37
    v_and_b32 v52, v225, v4
    v_and_b32 v53, v225, v5
    v_and_b32 v54, v225, v6
    v_and_b32 v55, v225, v7
    s_waitcnt vmcnt(1)
    global_load_dwordx4 v[220:223], v[60:61], off offset:3456 nt
    v_mfma_f32_16x16x32_bf16 v[56:59], v[52:55], v[212:215], v[56:59]
    v_perm_b32 v225, v51, v51, s36
    v_and_b32 v8, v225, v4
    v_and_b32 v9, v225, v5
    v_and_b32 v10, v225, v6
    v_and_b32 v11, v225, v7
    s_waitcnt vmcnt(1)
    s_nop 0
    v_mfma_f32_16x16x32_bf16 v[56:59], v[8:11], v[216:219], v[56:59]
    v_perm_b32 v225, v51, v51, s37
    v_and_b32 v52, v225, v4
    v_and_b32 v53, v225, v5
    v_and_b32 v54, v225, v6
    v_and_b32 v55, v225, v7
    s_waitcnt vmcnt(0)
    s_nop 0
    v_mfma_f32_16x16x32_bf16 v[56:59], v[52:55], v[220:223], v[56:59]
    v_lshlrev_b32 v3, 4, v1
    v_lshl_add_u32 v3, v2, 5, v3
    s_lshl_b32 s21, s20, 9
    v_add3_u32 v226, v3, s21, v228
    s_mov_b32 exec_hi, 0
    s_nop 2
    ds_write_b128 v226, v[56:59] offset:2560
    s_mov_b64 exec, -1
    v_mov_b32 v225, 1
    s_waitcnt lgkmcnt(0)
    s_mov_b64 exec, 1
    ds_add_u32 v228, v225 offset:40
    s_mov_b64 exec, -1
    s_mov_b32 s8, s32
    s_mov_b32 s9, s33
    s_mov_b32 s10, 2211840
    s_mov_b32 s11, 0x20000
    s_lshl_b32 s21, s20, 4
    v_lshl_add_u32 v224, v1, 2, s21
    s_movk_i32 s21, 1280
    v_mul_lo_u32 v62, v224, s21
    v_lshl_add_u32 v62, v2, 4, v62
    s_mul_i32 s22, s62, 81920
    s_add_u32 s21, s22, 0
    buffer_load_dwordx4 v[64:67], v62, s[8:11], s21 offen offset:0 nt
    s_add_u32 s21, s22, 0
    buffer_load_dwordx4 v[68:71], v62, s[8:11], s21 offen offset:256 nt
    s_waitcnt vmcnt(1)
    s_add_u32 s21, s22, 0
    buffer_load_dwordx4 v[72:75], v62, s[8:11], s21 offen offset:512 nt
    s_waitcnt vmcnt(1)
    s_add_u32 s21, s22, 0
    buffer_load_dwordx4 v[76:79], v62, s[8:11], s21 offen offset:768 nt
    s_waitcnt vmcnt(1)
    s_add_u32 s21, s22, 0
    buffer_load_dwordx4 v[80:83], v62, s[8:11], s21 offen offset:1024 nt
    s_waitcnt vmcnt(1)
    s_add_u32 s21, s22, 1280
    buffer_load_dwordx4 v[84:87], v62, s[8:11], s21 offen offset:0 nt
    s_waitcnt vmcnt(1)
    s_add_u32 s21, s22, 1280
    buffer_load_dwordx4 v[88:91], v62, s[8:11], s21 offen offset:256 nt
    s_waitcnt vmcnt(1)
    s_add_u32 s21, s22, 1280
    buffer_load_dwordx4 v[92:95], v62, s[8:11], s21 offen offset:512 nt
    s_waitcnt vmcnt(1)
    s_add_u32 s21, s22, 1280
    buffer_load_dwordx4 v[96:99], v62, s[8:11], s21 offen offset:768 nt
    s_waitcnt vmcnt(1)
    s_add_u32 s21, s22, 1280
    buffer_load_dwordx4 v[100:103], v62, s[8:11], s21 offen offset:1024 nt
    s_waitcnt vmcnt(1)
    s_add_u32 s21, s22, 2560
    buffer_load_dwordx4 v[104:107], v62, s[8:11], s21 offen offset:0 nt
    s_waitcnt vmcnt(1)
    s_add_u32 s21, s22, 2560
    buffer_load_dwordx4 v[108:111], v62, s[8:11], s21 offen offset:256 nt
    s_waitcnt vmcnt(1)
    s_add_u32 s21, s22, 2560
    buffer_load_dwordx4 v[112:115], v62, s[8:11], s21 offen offset:512 nt
    s_waitcnt vmcnt(1)
    s_add_u32 s21, s22, 2560
    buffer_load_dwordx4 v[116:119], v62, s[8:11], s21 offen offset:768 nt
    s_waitcnt vmcnt(1)
    s_add_u32 s21, s22, 2560
    buffer_load_dwordx4 v[120:123], v62, s[8:11], s21 offen offset:1024 nt
    s_waitcnt vmcnt(1)
    s_add_u32 s21, s22, 3840
    buffer_load_dwordx4 v[124:127], v62, s[8:11], s21 offen offset:0 nt
    s_waitcnt vmcnt(1)
    s_add_u32 s21, s22, 3840
    buffer_load_dwordx4 v[128:131], v62, s[8:11], s21 offen offset:256 nt
    s_waitcnt vmcnt(1)
    s_add_u32 s21, s22, 3840
    buffer_load_dwordx4 v[132:135], v62, s[8:11], s21 offen offset:512 nt
    s_waitcnt vmcnt(1)
    s_add_u32 s21, s22, 3840
    buffer_load_dwordx4 v[136:139], v62, s[8:11], s21 offen offset:768 nt
    s_waitcnt vmcnt(1)
    s_add_u32 s21, s22, 3840
    buffer_load_dwordx4 v[140:143], v62, s[8:11], s21 offen offset:1024 nt
    s_mov_b32 s42, 262144
L_spin_11:
    ds_read_b32 v225, v228 offset:40
    s_waitcnt lgkmcnt(0)
    v_readfirstlane_b32 s43, v225
    s_nop 0
    s_cmp_ge_i32 s43, 4
    s_cbranch_scc1 L_spun_12
    s_sleep 2
    s_sub_u32 s42, s42, 1
    s_cmp_lg_u32 s42, 0
    s_cbranch_scc1 L_spin_11
L_spun_12:
    v_lshl_add_u32 v224, v224, 2, v228
    ds_read_b128 v[160:163], v224 offset:2560
    ds_read_b128 v[164:167], v224 offset:2816
    ds_read_b128 v[168:171], v224 offset:3072
    ds_read_b128 v[172:175], v224 offset:3328
    ds_read_b128 v[176:179], v224 offset:3584
    ds_read_b128 v[180:183], v224 offset:3840
    ds_read_b128 v[184:187], v224 offset:4096
    ds_read_b128 v[188:191], v224 offset:4352
    s_waitcnt lgkmcnt(0)
    v_add_f32 v160, v160, v168
    v_add_f32 v176, v176, v184
    v_add_f32 v161, v161, v169
    v_add_f32 v177, v177, v185
    v_add_f32 v162, v162, v170
    v_add_f32 v178, v178, v186
    v_add_f32 v163, v163, v171
    v_add_f32 v179, v179, v187
    v_add_f32 v164, v164, v172
    v_add_f32 v180, v180, v188
    v_add_f32 v165, v165, v173
    v_add_f32 v181, v181, v189
    v_add_f32 v166, v166, v174
    v_add_f32 v182, v182, v190
    v_add_f32 v167, v167, v175
    v_add_f32 v183, v183, v191
    v_add_f32 v160, v160, v176
    v_add_f32 v161, v161, v177
    v_add_f32 v162, v162, v178
    v_add_f32 v163, v163, v179
    v_add_f32 v164, v164, v180
    v_add_f32 v165, v165, v181
    v_add_f32 v166, v166, v182
    v_add_f32 v167, v167, v183
    v_cvt_pk_bf16_f32 v225, v160, v164
    v_lshlrev_b32 v160, 16, v225
    v_and_b32 v164, 0xffff0000, v225
    v_max_f32 v160, 0, v160
    v_mul_f32 v160, v160, v164
    v_cvt_pk_bf16_f32 v160, v160, v160
    v_and_b32 v160, 0xffff0000, v160
    v_mul_f32 v160, v160, v230
    v_cvt_pk_bf16_f32 v225, v161, v165
    v_lshlrev_b32 v161, 16, v225
    v_and_b32 v165, 0xffff0000, v225
    v_max_f32 v161, 0, v161
    v_mul_f32 v161, v161, v165
    v_cvt_pk_bf16_f32 v161, v161, v161
    v_and_b32 v161, 0xffff0000, v161
    v_mul_f32 v161, v161, v230
    v_cvt_pk_bf16_f32 v225, v162, v166
    v_lshlrev_b32 v162, 16, v225
    v_and_b32 v166, 0xffff0000, v225
    v_max_f32 v162, 0, v162
    v_mul_f32 v162, v162, v166
    v_cvt_pk_bf16_f32 v162, v162, v162
    v_and_b32 v162, 0xffff0000, v162
    v_mul_f32 v162, v162, v230
    v_cvt_pk_bf16_f32 v225, v163, v167
    v_lshlrev_b32 v163, 16, v225
    v_and_b32 v167, 0xffff0000, v225
    v_max_f32 v163, 0, v163
    v_mul_f32 v163, v163, v167
    v_cvt_pk_bf16_f32 v163, v163, v163
    v_and_b32 v163, 0xffff0000, v163
    v_mul_f32 v163, v163, v230
    v_cvt_pk_bf16_f32 v225, v160, v160
    v_and_b32 v8, v225, v4
    v_and_b32 v9, v225, v5
    v_and_b32 v10, v225, v6
    v_and_b32 v11, v225, v7
    s_waitcnt vmcnt(0)
    s_nop 0
    v_mfma_f32_16x16x32_bf16 v[12:15], v[8:11], v[64:67], v[12:15]
    v_mfma_f32_16x16x32_bf16 v[16:19], v[8:11], v[68:71], v[16:19]
    v_mfma_f32_16x16x32_bf16 v[20:23], v[8:11], v[72:75], v[20:23]
    v_mfma_f32_16x16x32_bf16 v[24:27], v[8:11], v[76:79], v[24:27]
    v_mfma_f32_16x16x32_bf16 v[28:31], v[8:11], v[80:83], v[28:31]
    v_cvt_pk_bf16_f32 v225, v161, v161
    v_and_b32 v52, v225, v4
    v_and_b32 v53, v225, v5
    v_and_b32 v54, v225, v6
    v_and_b32 v55, v225, v7
    s_nop 1
    v_mfma_f32_16x16x32_bf16 v[12:15], v[52:55], v[84:87], v[12:15]
    v_mfma_f32_16x16x32_bf16 v[16:19], v[52:55], v[88:91], v[16:19]
    v_mfma_f32_16x16x32_bf16 v[20:23], v[52:55], v[92:95], v[20:23]
    v_mfma_f32_16x16x32_bf16 v[24:27], v[52:55], v[96:99], v[24:27]
    v_mfma_f32_16x16x32_bf16 v[28:31], v[52:55], v[100:103], v[28:31]
    v_cvt_pk_bf16_f32 v225, v162, v162
    v_and_b32 v8, v225, v4
    v_and_b32 v9, v225, v5
    v_and_b32 v10, v225, v6
    v_and_b32 v11, v225, v7
    s_nop 1
    v_mfma_f32_16x16x32_bf16 v[12:15], v[8:11], v[104:107], v[12:15]
    v_mfma_f32_16x16x32_bf16 v[16:19], v[8:11], v[108:111], v[16:19]
    v_mfma_f32_16x16x32_bf16 v[20:23], v[8:11], v[112:115], v[20:23]
    v_mfma_f32_16x16x32_bf16 v[24:27], v[8:11], v[116:119], v[24:27]
    v_mfma_f32_16x16x32_bf16 v[28:31], v[8:11], v[120:123], v[28:31]
    v_cvt_pk_bf16_f32 v225, v163, v163
    v_and_b32 v52, v225, v4
    v_and_b32 v53, v225, v5
    v_and_b32 v54, v225, v6
    v_and_b32 v55, v225, v7
    s_nop 1
    v_mfma_f32_16x16x32_bf16 v[12:15], v[52:55], v[124:127], v[12:15]
    v_mfma_f32_16x16x32_bf16 v[16:19], v[52:55], v[128:131], v[16:19]
    v_mfma_f32_16x16x32_bf16 v[20:23], v[52:55], v[132:135], v[20:23]
    v_mfma_f32_16x16x32_bf16 v[24:27], v[52:55], v[136:139], v[24:27]
    v_mfma_f32_16x16x32_bf16 v[28:31], v[52:55], v[140:143], v[28:31]
L_s_noffn:
    s_mov_b32 s8, s26
    s_mov_b32 s9, s27
    s_mov_b32 s10, 5242880
    s_mov_b32 s11, 0x20000
    s_lshl_b32 s21, s20, 5
    v_lshl_add_u32 v224, v1, 2, s21
    s_movk_i32 s21, 1280
    v_mul_lo_u32 v62, v224, s21
    v_lshl_add_u32 v62, v2, 4, v62
    s_mul_i32 s22, s16, 163840
    s_add_u32 s21, s22, 0
    buffer_load_dwordx4 v[64:67], v62, s[8:11], s21 offen offset:0 nt
    s_add_u32 s21, s22, 0
    buffer_load_dwordx4 v[68:71], v62, s[8:11], s21 offen offset:256 nt
    s_waitcnt vmcnt(1)
    s_add_u32 s21, s22, 0
    buffer_load_dwordx4 v[72:75], v62, s[8:11], s21 offen offset:512 nt
    s_waitcnt vmcnt(1)
    s_add_u32 s21, s22, 0
    buffer_load_dwordx4 v[76:79], v62, s[8:11], s21 offen offset:768 nt
    s_waitcnt vmcnt(1)
    s_add_u32 s21, s22, 0
    buffer_load_dwordx4 v[80:83], v62, s[8:11], s21 offen offset:1024 nt
    s_waitcnt vmcnt(1)
    s_add_u32 s21, s22, 1280
    buffer_load_dwordx4 v[84:87], v62, s[8:11], s21 offen offset:0 nt
    s_waitcnt vmcnt(1)
    s_add_u32 s21, s22, 1280
    buffer_load_dwordx4 v[88:91], v62, s[8:11], s21 offen offset:256 nt
    s_waitcnt vmcnt(1)
    s_add_u32 s21, s22, 1280
    buffer_load_dwordx4 v[92:95], v62, s[8:11], s21 offen offset:512 nt
    s_waitcnt vmcnt(1)
    s_add_u32 s21, s22, 1280
    buffer_load_dwordx4 v[96:99], v62, s[8:11], s21 offen offset:768 nt
    s_waitcnt vmcnt(1)
    s_add_u32 s21, s22, 1280
    buffer_load_dwordx4 v[100:103], v62, s[8:11], s21 offen offset:1024 nt
    s_waitcnt vmcnt(1)
    s_add_u32 s21, s22, 2560
    buffer_load_dwordx4 v[104:107], v62, s[8:11], s21 offen offset:0 nt
    s_waitcnt vmcnt(1)
    s_add_u32 s21, s22, 2560
    buffer_load_dwordx4 v[108:111], v62, s[8:11], s21 offen offset:256 nt
    s_waitcnt vmcnt(1)
    s_add_u32 s21, s22, 2560
    buffer_load_dwordx4 v[112:115], v62, s[8:11], s21 offen offset:512 nt
    s_waitcnt vmcnt(1)
    s_add_u32 s21, s22, 2560
    buffer_load_dwordx4 v[116:119], v62, s[8:11], s21 offen offset:768 nt
    s_waitcnt vmcnt(1)
    s_add_u32 s21, s22, 2560
    buffer_load_dwordx4 v[120:123], v62, s[8:11], s21 offen offset:1024 nt
    s_waitcnt vmcnt(1)
    s_add_u32 s21, s22, 3840
    buffer_load_dwordx4 v[124:127], v62, s[8:11], s21 offen offset:0 nt
    s_waitcnt vmcnt(1)
    s_add_u32 s21, s22, 3840
    buffer_load_dwordx4 v[128:131], v62, s[8:11], s21 offen offset:256 nt
    s_waitcnt vmcnt(1)
    s_add_u32 s21, s22, 3840
    buffer_load_dwordx4 v[132:135], v62, s[8:11], s21 offen offset:512 nt
    s_waitcnt vmcnt(1)
    s_add_u32 s21, s22, 3840
    buffer_load_dwordx4 v[136:139], v62, s[8:11], s21 offen offset:768 nt
    s_waitcnt vmcnt(1)
    s_add_u32 s21, s22, 3840
    buffer_load_dwordx4 v[140:143], v62, s[8:11], s21 offen offset:1024 nt
    s_waitcnt vmcnt(1)
    s_add_u32 s21, s22, 20480
    buffer_load_dwordx4 v[144:147], v62, s[8:11], s21 offen offset:0 nt
    s_waitcnt vmcnt(1)
    s_add_u32 s21, s22, 20480
    buffer_load_dwordx4 v[148:151], v62, s[8:11], s21 offen offset:256 nt
    s_waitcnt vmcnt(1)
    s_add_u32 s21, s22, 20480
    buffer_load_dwordx4 v[152:155], v62, s[8:11], s21 offen offset:512 nt
    s_waitcnt vmcnt(1)
    s_add_u32 s21, s22, 20480
    buffer_load_dwordx4 v[156:159], v62, s[8:11], s21 offen offset:768 nt
    s_waitcnt vmcnt(1)
    s_add_u32 s21, s22, 20480
    buffer_load_dwordx4 v[160:163], v62, s[8:11], s21 offen offset:1024 nt
    s_waitcnt vmcnt(1)
    s_add_u32 s21, s22, 21760
    buffer_load_dwordx4 v[164:167], v62, s[8:11], s21 offen offset:0 nt
    s_waitcnt vmcnt(1)
    s_add_u32 s21, s22, 21760
    buffer_load_dwordx4 v[168:171], v62, s[8:11], s21 offen offset:256 nt
    s_waitcnt vmcnt(1)
    s_add_u32 s21, s22, 21760
    buffer_load_dwordx4 v[172:175], v62, s[8:11], s21 offen offset:512 nt
    s_waitcnt vmcnt(1)
    s_add_u32 s21, s22, 21760
    buffer_load_dwordx4 v[176:179], v62, s[8:11], s21 offen offset:768 nt
    s_waitcnt vmcnt(1)
    s_add_u32 s21, s22, 21760
    buffer_load_dwordx4 v[180:183], v62, s[8:11], s21 offen offset:1024 nt
    s_waitcnt vmcnt(1)
    s_add_u32 s21, s22, 23040
    buffer_load_dwordx4 v[184:187], v62, s[8:11], s21 offen offset:0 nt
    s_waitcnt vmcnt(1)
    s_add_u32 s21, s22, 23040
    buffer_load_dwordx4 v[188:191], v62, s[8:11], s21 offen offset:256 nt
    s_waitcnt vmcnt(1)
    s_add_u32 s21, s22, 23040
    buffer_load_dwordx4 v[192:195], v62, s[8:11], s21 offen offset:512 nt
    s_waitcnt vmcnt(1)
    s_add_u32 s21, s22, 23040
    buffer_load_dwordx4 v[196:199], v62, s[8:11], s21 offen offset:768 nt
    s_waitcnt vmcnt(1)
    s_add_u32 s21, s22, 23040
    buffer_load_dwordx4 v[200:203], v62, s[8:11], s21 offen offset:1024 nt
    s_waitcnt vmcnt(1)
    s_add_u32 s21, s22, 24320
    buffer_load_dwordx4 v[204:207], v62, s[8:11], s21 offen offset:0 nt
    s_waitcnt vmcnt(1)
    s_add_u32 s21, s22, 24320
    buffer_load_dwordx4 v[208:211], v62, s[8:11], s21 offen offset:256 nt
    s_waitcnt vmcnt(1)
    s_add_u32 s21, s22, 24320
    buffer_load_dwordx4 v[212:215], v62, s[8:11], s21 offen offset:512 nt
    s_waitcnt vmcnt(1)
    s_add_u32 s21, s22, 24320
    buffer_load_dwordx4 v[216:219], v62, s[8:11], s21 offen offset:768 nt
    s_waitcnt vmcnt(1)
    s_add_u32 s21, s22, 24320
    buffer_load_dwordx4 v[220:223], v62, s[8:11], s21 offen offset:1024 nt
    s_waitcnt vmcnt(0)
    s_cmp_lg_u32 s20, 0
    s_cbranch_scc1 L_s_noarr
    s_mov_b32 s42, 262144
L_spin_13:
    ds_read_b32 v225, v228 offset:0
    s_waitcnt lgkmcnt(0)
    v_readfirstlane_b32 s43, v225
    s_nop 0
    s_cmp_ge_i32 s43, 496
    s_cbranch_scc1 L_spun_14
    s_sleep 32
    s_sub_u32 s42, s42, 1
    s_cmp_lg_u32 s42, 0
    s_cbranch_scc1 L_spin_13
L_spun_14:
    s_mov_b32 s42, 262144
L_spin_15:
    ds_read_b32 v225, v228 offset:0
    s_waitcnt lgkmcnt(0)
    v_readfirstlane_b32 s43, v225
    s_nop 0
    s_cmp_ge_i32 s43, 506
    s_cbranch_scc1 L_spun_16
    s_sleep 2
    s_sub_u32 s42, s42, 1
    s_cmp_lg_u32 s42, 0
    s_cbranch_scc1 L_spin_15
L_spun_16:
    s_lshl_b32 s21, s17, 2
    v_mov_b32 v226, s21
    v_mov_b32 v225, 1
    s_mov_b64 exec, 1
    buffer_atomic_add v225, v226, s[68:71], 0 offen sc0
    s_waitcnt vmcnt(0)
    ds_write_b32 v228, v225 offset:44
    s_mov_b64 exec, -1
    s_waitcnt lgkmcnt(0)
L_s_noarr:
    s_load_dwordx2 s[12:13], s[0:1], 80
    s_load_dwordx2 s[76:77], s[0:1], 96
    v_lshl_add_u32 v224, v224, 2, v228
    s_waitcnt lgkmcnt(0)
    s_mul_i32 s21, s17, 1280
    s_add_u32 s12, s12, s21
    s_addc_u32 s13, s13, 0
    s_mov_b32 s14, 1280
    s_mov_b32 s15, 0x20000
    s_mul_i32 s21, s18, 2048
    s_add_u32 s76, s76, s21
    s_addc_u32 s77, s77, 0
    s_mov_b32 s78, 1280
    s_mov_b32 s79, 0x20000
    s_mov_b32 s42, 262144
L_spin_17:
    ds_read_b32 v225, v228 offset:0
    s_waitcnt lgkmcnt(0)
    v_readfirstlane_b32 s43, v225
    s_nop 0
    s_cmp_ge_i32 s43, 498
    s_cbranch_scc1 L_spun_18
    s_sleep 32
    s_sub_u32 s42, s42, 1
    s_cmp_lg_u32 s42, 0
    s_cbranch_scc1 L_spin_17
L_spun_18:
    s_mov_b32 s42, 262144
L_spin_19:
    ds_read_b32 v225, v228 offset:48
    s_waitcnt lgkmcnt(0)
    v_readfirstlane_b32 s43, v225
    s_nop 0
    s_cmp_ge_i32 s43, 3
    s_cbranch_scc1 L_spun_20
    s_sleep 2
    s_sub_u32 s42, s42, 1
    s_cmp_lg_u32 s42, 0
    s_cbranch_scc1 L_spin_19
L_spun_20:
    ds_read_b64 v[232:233], v228 offset:5120
    ds_read_b64 v[234:235], v228 offset:6144
    ds_read_b64 v[236:237], v228 offset:7168
    s_waitcnt lgkmcnt(0)
    v_max3_f32 v225, v232, v234, v236
    v_sub_f32 v232, v232, v225
    v_sub_f32 v234, v234, v225
    v_sub_f32 v236, v236, v225
    v_exp_f32 v232, v232
    v_exp_f32 v234, v234
    v_exp_f32 v236, v236
    v_mul_f32 v225, v232, v233
    v_fma_f32 v225, v234, v235, v225
    v_fma_f32 v225, v236, v237, v225
    v_rcp_f32 v225, v225
    s_nop 0
    v_mul_f32 v225, v225, v229
    v_mul_f32 v232, v232, v225
    v_mul_f32 v234, v234, v225
    v_mul_f32 v236, v236, v225
    s_setprio 3
    s_barrier
    ds_read_b128 v[32:35], v224 offset:4608
    ds_read_b128 v[36:39], v224 offset:4672
    ds_read_b128 v[40:43], v224 offset:5632
    ds_read_b128 v[44:47], v224 offset:5696
    ds_read_b128 v[48:51], v224 offset:6656
    ds_read_b128 v[52:55], v224 offset:6720
    s_waitcnt lgkmcnt(0)
    v_mul_f32 v240, v32, v232
    v_fma_f32 v240, v40, v234, v240
    v_fma_f32 v240, v48, v236, v240
    v_cvt_pk_bf16_f32 v225, v240, v240
    v_and_b32 v56, v225, v4
    v_and_b32 v57, v225, v5
    v_and_b32 v58, v225, v6
    v_and_b32 v59, v225, v7
    s_nop 1
    v_mfma_f32_16x16x32_bf16 v[12:15], v[56:59], v[64:67], v[12:15]
    v_mul_f32 v241, v33, v232
    v_fma_f32 v241, v41, v234, v241
    v_fma_f32 v241, v49, v236, v241
    v_mfma_f32_16x16x32_bf16 v[16:19], v[56:59], v[68:71], v[16:19]
    v_cvt_pk_bf16_f32 v225, v241, v241
    v_and_b32 v8, v225, v4
    v_mfma_f32_16x16x32_bf16 v[20:23], v[56:59], v[72:75], v[20:23]
    v_and_b32 v9, v225, v5
    v_and_b32 v10, v225, v6
    v_and_b32 v11, v225, v7
    v_mfma_f32_16x16x32_bf16 v[24:27], v[56:59], v[76:79], v[24:27]
    v_mfma_f32_16x16x32_bf16 v[28:31], v[56:59], v[80:83], v[28:31]
    v_mfma_f32_16x16x32_bf16 v[12:15], v[8:11], v[84:87], v[12:15]
    v_mul_f32 v242, v34, v232
    v_fma_f32 v242, v42, v234, v242
    v_fma_f32 v242, v50, v236, v242
    v_mfma_f32_16x16x32_bf16 v[16:19], v[8:11], v[88:91], v[16:19]
    v_cvt_pk_bf16_f32 v225, v242, v242
    v_and_b32 v56, v225, v4
    v_mfma_f32_16x16x32_bf16 v[20:23], v[8:11], v[92:95], v[20:23]
    v_and_b32 v57, v225, v5
    v_and_b32 v58, v225, v6
    v_and_b32 v59, v225, v7
    v_mfma_f32_16x16x32_bf16 v[24:27], v[8:11], v[96:99], v[24:27]
    v_mfma_f32_16x16x32_bf16 v[28:31], v[8:11], v[100:103], v[28:31]
    v_mfma_f32_16x16x32_bf16 v[12:15], v[56:59], v[104:107], v[12:15]
    v_mul_f32 v243, v35, v232
    v_fma_f32 v243, v43, v234, v243
    v_fma_f32 v243, v51, v236, v243
    v_mfma_f32_16x16x32_bf16 v[16:19], v[56:59], v[108:111], v[16:19]
    v_cvt_pk_bf16_f32 v225, v243, v243
    v_and_b32 v8, v225, v4
    v_mfma_f32_16x16x32_bf16 v[20:23], v[56:59], v[112:115], v[20:23]
    v_and_b32 v9, v225, v5
    v_and_b32 v10, v225, v6
    v_and_b32 v11, v225, v7
    v_mfma_f32_16x16x32_bf16 v[24:27], v[56:59], v[116:119], v[24:27]
    v_mfma_f32_16x16x32_bf16 v[28:31], v[56:59], v[120:123], v[28:31]
    v_mfma_f32_16x16x32_bf16 v[12:15], v[8:11], v[124:127], v[12:15]
    v_mul_f32 v244, v36, v232
    v_fma_f32 v244, v44, v234, v244
    v_fma_f32 v244, v52, v236, v244
    v_mfma_f32_16x16x32_bf16 v[16:19], v[8:11], v[128:131], v[16:19]
    v_cvt_pk_bf16_f32 v225, v244, v244
    v_and_b32 v56, v225, v4
    v_mfma_f32_16x16x32_bf16 v[20:23], v[8:11], v[132:135], v[20:23]
    v_and_b32 v57, v225, v5
    v_and_b32 v58, v225, v6
    v_and_b32 v59, v225, v7
    v_mfma_f32_16x16x32_bf16 v[24:27], v[8:11], v[136:139], v[24:27]
    v_mfma_f32_16x16x32_bf16 v[28:31], v[8:11], v[140:143], v[28:31]
    v_mfma_f32_16x16x32_bf16 v[12:15], v[56:59], v[144:147], v[12:15]
    v_mul_f32 v245, v37, v232
    v_fma_f32 v245, v45, v234, v245
    v_fma_f32 v245, v53, v236, v245
    v_mfma_f32_16x16x32_bf16 v[16:19], v[56:59], v[148:151], v[16:19]
    v_cvt_pk_bf16_f32 v225, v245, v245
    v_and_b32 v8, v225, v4
    v_mfma_f32_16x16x32_bf16 v[20:23], v[56:59], v[152:155], v[20:23]
    v_and_b32 v9, v225, v5
    v_and_b32 v10, v225, v6
    v_and_b32 v11, v225, v7
    v_mfma_f32_16x16x32_bf16 v[24:27], v[56:59], v[156:159], v[24:27]
    v_mfma_f32_16x16x32_bf16 v[28:31], v[56:59], v[160:163], v[28:31]
    v_mfma_f32_16x16x32_bf16 v[12:15], v[8:11], v[164:167], v[12:15]
    v_mul_f32 v246, v38, v232
    v_fma_f32 v246, v46, v234, v246
    v_fma_f32 v246, v54, v236, v246
    v_mfma_f32_16x16x32_bf16 v[16:19], v[8:11], v[168:171], v[16:19]
    v_cvt_pk_bf16_f32 v225, v246, v246
    v_and_b32 v56, v225, v4
    v_mfma_f32_16x16x32_bf16 v[20:23], v[8:11], v[172:175], v[20:23]
    v_and_b32 v57, v225, v5
    v_and_b32 v58, v225, v6
    v_and_b32 v59, v225, v7
    v_mfma_f32_16x16x32_bf16 v[24:27], v[8:11], v[176:179], v[24:27]
    v_mfma_f32_16x16x32_bf16 v[28:31], v[8:11], v[180:183], v[28:31]
    v_mfma_f32_16x16x32_bf16 v[12:15], v[56:59], v[184:187], v[12:15]
    v_mul_f32 v247, v39, v232
    v_fma_f32 v247, v47, v234, v247
    v_fma_f32 v247, v55, v236, v247
    v_mfma_f32_16x16x32_bf16 v[16:19], v[56:59], v[188:191], v[16:19]
    v_cvt_pk_bf16_f32 v225, v247, v247
    v_and_b32 v8, v225, v4
    v_mfma_f32_16x16x32_bf16 v[20:23], v[56:59], v[192:195], v[20:23]
    v_and_b32 v9, v225, v5
    v_and_b32 v10, v225, v6
    v_and_b32 v11, v225, v7
    v_mfma_f32_16x16x32_bf16 v[24:27], v[56:59], v[196:199], v[24:27]
    v_mfma_f32_16x16x32_bf16 v[28:31], v[56:59], v[200:203], v[28:31]
    v_mfma_f32_16x16x32_bf16 v[12:15], v[8:11], v[204:207], v[12:15]
    v_mfma_f32_16x16x32_bf16 v[16:19], v[8:11], v[208:211], v[16:19]
    v_mfma_f32_16x16x32_bf16 v[20:23], v[8:11], v[212:215], v[20:23]
    v_mfma_f32_16x16x32_bf16 v[24:27], v[8:11], v[216:219], v[24:27]
    v_mfma_f32_16x16x32_bf16 v[28:31], v[8:11], v[220:223], v[28:31]
    v_lshlrev_b32 v3, 4, v1
    v_lshl_add_u32 v3, v2, 5, v3
    s_mul_i32 s21, s20, 2560
    v_add_u32 v226, s21, v3
    s_mov_b32 exec_hi, 0
    ds_write_b128 v226, v[12:15] offset:0
    ds_write_b128 v226, v[16:19] offset:512
    ds_write_b128 v226, v[20:23] offset:1024
    ds_write_b128 v226, v[24:27] offset:1536
    ds_write_b128 v226, v[28:31] offset:2048
    s_mov_b64 exec, -1
    s_waitcnt lgkmcnt(0)
    s_barrier
    s_cmp_ge_u32 s20, 3
    s_cbranch_scc1 L_end
    ds_read_b32 v225, v228 offset:44
    s_lshl_b32 s21, s20, 10
    v_lshl_add_u32 v226, v0, 4, s21
    ds_read_b128 v[64:67], v226 offset:0
    ds_read_b128 v[68:71], v226 offset:2560
    ds_read_b128 v[72:75], v226 offset:5120
    ds_read_b128 v[76:79], v226 offset:7680
    s_waitcnt lgkmcnt(4)
    v_readfirstlane_b32 s22, v225
    s_nop 0
    s_cmp_lg_u32 s22, 31
    s_cbranch_scc1 L_pub
    ds_read_b128 v[80:83], v226 offset:10240
    ds_read_b128 v[84:87], v226 offset:12800
    ds_read_b128 v[88:91], v226 offset:15360
    ds_read_b128 v[92:95], v226 offset:17920
    v_lshrrev_b32 v226, 1, v226
    s_waitcnt lgkmcnt(0)
    v_pk_add_f32 v[64:65], v[64:65], v[68:69]
    v_pk_add_f32 v[66:67], v[66:67], v[70:71]
    v_pk_add_f32 v[72:73], v[72:73], v[76:77]
    v_pk_add_f32 v[74:75], v[74:75], v[78:79]
    v_pk_add_f32 v[80:81], v[80:81], v[84:85]
    v_pk_add_f32 v[82:83], v[82:83], v[86:87]
    v_pk_add_f32 v[88:89], v[88:89], v[92:93]
    v_pk_add_f32 v[90:91], v[90:91], v[94:95]
    v_pk_add_f32 v[64:65], v[64:65], v[72:73]
    v_pk_add_f32 v[66:67], v[66:67], v[74:75]
    v_pk_add_f32 v[80:81], v[80:81], v[88:89]
    v_pk_add_f32 v[82:83], v[82:83], v[90:91]
    v_cvt_pk_bf16_f32 v64, v64, v65
    v_cvt_pk_bf16_f32 v66, v66, v67
    v_and_b32 v65, 0xffff0000, v64
    v_lshlrev_b32 v64, 16, v64
    v_and_b32 v67, 0xffff0000, v66
    v_lshlrev_b32 v66, 16, v66
    v_pk_add_f32 v[64:65], v[64:65], v[80:81]
    v_pk_add_f32 v[66:67], v[66:67], v[82:83]
    v_cvt_pk_bf16_f32 v64, v64, v65
    v_cvt_pk_bf16_f32 v65, v66, v67
    buffer_store_dwordx2 v[64:65], v226, s[12:15], 0 offen
    s_endpgm
L_pub:
    v_lshrrev_b32 v226, 1, v226
    s_waitcnt lgkmcnt(0)
    v_pk_add_f32 v[64:65], v[64:65], v[68:69]
    v_pk_add_f32 v[66:67], v[66:67], v[70:71]
    v_pk_add_f32 v[72:73], v[72:73], v[76:77]
    v_pk_add_f32 v[74:75], v[74:75], v[78:79]
    v_pk_add_f32 v[64:65], v[64:65], v[72:73]
    v_pk_add_f32 v[66:67], v[66:67], v[74:75]
    v_cvt_pk_bf16_f32 v64, v64, v65
    v_cvt_pk_bf16_f32 v65, v66, v67
    v_min_u32 v64, -2, v64
    v_min_u32 v65, -2, v65
    buffer_store_dwordx2 v[64:65], v226, s[76:79], 0 offen sc1
    s_endpgm
L_join:
    s_setprio 0
    v_mov_b32 v1, 147456
    s_waitcnt lgkmcnt(0)
    s_barrier
    ds_read_b32 v2, v1 offset:44
    s_waitcnt lgkmcnt(0)
    v_readfirstlane_b32 s21, v2
    s_nop 0
    s_cmp_lg_u32 s21, 31
    s_cbranch_scc1 L_join3
    v_lshrrev_b32 v1, 4, v0
    v_and_b32 v2, 15, v0
    v_lshlrev_b32 v3, 11, v1
    v_lshl_add_u32 v3, v2, 4, v3
    s_lshl_b32 s22, s19, 3
    s_add_u32 s23, s22, 0
    v_add_u32 v4, s23, v1
    v_cmp_eq_u32 vcc, s16, v4
    v_mov_b32 v5, 0x40000000
    s_nop 0
    v_cndmask_b32 v6, v3, v5, vcc
    s_add_u32 s23, s22, 4
    v_add_u32 v4, s23, v1
    v_cmp_eq_u32 vcc, s16, v4
    v_mov_b32 v5, 0x40000000
    s_nop 0
    v_cndmask_b32 v7, v3, v5, vcc
    v_and_b32 v4, 15, v0
    v_and_b32 v5, 1, v0
    v_sub_u32 v5, 0, v5
    v_xor_b32 v5, 0xffff, v5
    v_lshrrev_b32 v4, 1, v4
    v_cmp_eq_u32 vcc, 0, v4
    s_nop 1
    v_cndmask_b32 v8, 0, v5, vcc
    v_cmp_eq_u32 vcc, 1, v4
    s_nop 1
    v_cndmask_b32 v9, 0, v5, vcc
    v_cmp_eq_u32 vcc, 2, v4
    s_nop 1
    v_cndmask_b32 v10, 0, v5, vcc
    v_cmp_eq_u32 vcc, 3, v4
    s_nop 1
    v_cndmask_b32 v11, 0, v5, vcc
    v_and_b32 v8, 0x3f803f80, v8
    v_and_b32 v9, 0x3f803f80, v9
    v_and_b32 v10, 0x3f803f80, v10
    v_and_b32 v11, 0x3f803f80, v11
    s_mov_b32 s27, 0x4000
L_gather:
    s_add_u32 s23, s22, 0
    s_lshl_b32 s23, s23, 11
    buffer_load_dwordx4 v[16:19], v6, s[40:43], s23 offen offset:0 sc1
    buffer_load_dwordx4 v[20:23], v6, s[40:43], s23 offen offset:256 sc1
    buffer_load_dwordx4 v[24:27], v6, s[40:43], s23 offen offset:512 sc1
    buffer_load_dwordx4 v[28:31], v6, s[40:43], s23 offen offset:768 sc1
    buffer_load_dwordx4 v[32:35], v6, s[40:43], s23 offen offset:1024 sc1
    s_add_u32 s23, s22, 4
    s_lshl_b32 s23, s23, 11
    buffer_load_dwordx4 v[36:39], v7, s[40:43], s23 offen offset:0 sc1
    buffer_load_dwordx4 v[40:43], v7, s[40:43], s23 offen offset:256 sc1
    buffer_load_dwordx4 v[44:47], v7, s[40:43], s23 offen offset:512 sc1
    buffer_load_dwordx4 v[48:51], v7, s[40:43], s23 offen offset:768 sc1
    buffer_load_dwordx4 v[52:55], v7, s[40:43], s23 offen offset:1024 sc1
    s_waitcnt vmcnt(0)
    v_max3_u32 v4, v16, v17, v18
    v_max3_u32 v5, v19, v20, v21
    v_max3_u32 v4, v4, v22, v23
    v_max3_u32 v5, v5, v24, v25
    v_max3_u32 v4, v4, v26, v27
    v_max3_u32 v5, v5, v28, v29
    v_max3_u32 v4, v4, v30, v31
    v_max3_u32 v5, v5, v32, v33
    v_max3_u32 v4, v4, v34, v35
    v_max3_u32 v5, v5, v36, v37
    v_max3_u32 v4, v4, v38, v39
    v_max3_u32 v5, v5, v40, v41
    v_max3_u32 v4, v4, v42, v43
    v_max3_u32 v5, v5, v44, v45
    v_max3_u32 v4, v4, v46, v47
    v_max3_u32 v5, v5, v48, v49
    v_max3_u32 v4, v4, v50, v51
    v_max3_u32 v5, v5, v52, v53
    v_max3_u32 v4, v4, v54, v55
    v_max_u32 v4, v4, v5
    v_cmp_eq_u32 vcc, -1, v4
    s_nop 0
    s_cmp_eq_u64 vcc, 0
    s_cbranch_scc1 L_gathered
    s_sub_u32 s27, s27, 1
    s_cmp_lg_u32 s27, 0
    s_cbranch_scc1 L_gather
L_gathered:
    v_mfma_f32_16x16x32_bf16 v[64:67], v[8:11], v[16:19], 0
    v_mfma_f32_16x16x32_bf16 v[68:71], v[8:11], v[20:23], 0
    v_mfma_f32_16x16x32_bf16 v[72:75], v[8:11], v[24:27], 0
    v_mfma_f32_16x16x32_bf16 v[76:79], v[8:11], v[28:31], 0
    v_mfma_f32_16x16x32_bf16 v[80:83], v[8:11], v[32:35], 0
    v_mfma_f32_16x16x32_bf16 v[64:67], v[8:11], v[36:39], v[64:67]
    v_mfma_f32_16x16x32_bf16 v[68:71], v[8:11], v[40:43], v[68:71]
    v_mfma_f32_16x16x32_bf16 v[72:75], v[8:11], v[44:47], v[72:75]
    v_mfma_f32_16x16x32_bf16 v[76:79], v[8:11], v[48:51], v[76:79]
    v_mfma_f32_16x16x32_bf16 v[80:83], v[8:11], v[52:55], v[80:83]
    v_lshlrev_b32 v3, 4, v1
    v_lshl_add_u32 v3, v2, 5, v3
    s_add_u32 s21, s19, 4
    s_mul_i32 s21, s21, 2560
    v_add_u32 v3, s21, v3
    s_mov_b32 exec_hi, 0
    ds_write_b128 v3, v[64:67] offset:0
    ds_write_b128 v3, v[68:71] offset:512
    ds_write_b128 v3, v[72:75] offset:1024
    ds_write_b128 v3, v[76:79] offset:1536
    ds_write_b128 v3, v[80:83] offset:2048
    s_mov_b64 exec, -1
L_join3:
    s_waitcnt lgkmcnt(0)
    s_barrier
L_end:
    s_endpgm
.section .rodata,"a"
.p2align 6
.amdhsa_kernel gated_mix__gqa_block_cached__glu_gated_reglu__decode_kernel
  .amdhsa_next_free_vgpr 256
  .amdhsa_next_free_sgpr 102
  .amdhsa_accum_offset 256
  .amdhsa_group_segment_fixed_size 0
  .amdhsa_kernarg_size 104
  .amdhsa_user_sgpr_count 2
  .amdhsa_user_sgpr_kernarg_segment_ptr 1
  .amdhsa_system_sgpr_workgroup_id_x 1
.end_amdhsa_kernel
```
